```python
import torch

def _softmax(x, axis=-1):
    return torch.softmax(x, dim=axis)
def _gelu(x):
    return torch.nn.functional.gelu(x, approximate="tanh")
def _silu(x):
    return torch.nn.functional.silu(x)
def _sigmoid(x):
    return torch.sigmoid(x)
def _layernorm(x, axis=-1, eps=1e-5):
    m = x.mean(dim=axis, keepdim=True)
    v = x.var(dim=axis, keepdim=True, unbiased=False)
    return (x - m) / torch.sqrt(v + eps)
def _scatter_add(tgt, idx, src, axis=0):
    return tgt.clone().index_add_(axis, idx, src)
def _segment_sum(src, seg, n):
    out = torch.zeros((n,) + src.shape[1:], dtype=src.dtype)
    return out.index_add_(0, seg, src)
def _pad(x, pw):
    flat = tuple(v for pair in reversed(pw) for v in pair)
    return torch.nn.functional.pad(x, flat)

kernel_name = 'standalone__weight_only_int_quip__decode'

def setup_inputs():

    _w = (lambda a: (lambda t: t.to(torch.bfloat16) if t.is_floating_point() else t)(torch.as_tensor(a)))
    B, S, D, F = 4, 1, 576, 4608
    G = 32 if 32 > 0 else D
    D = (D // G) * G
    ng = D // G
    bits = 4 if 4 > 0 else 4
    qmax = 1 << bits
    qw = torch.randint(0, qmax, (D, F)).to(torch.int32)
    U, _ = (lambda *_a, **_k: torch.linalg.qr(*[torch.as_tensor(_x).float() for _x in _a], **_k))((lambda *s: torch.randn(*s, dtype=torch.bfloat16) * 0.05)(D, D))
    V, _ = (lambda *_a, **_k: torch.linalg.qr(*[torch.as_tensor(_x).float() for _x in _a], **_k))((lambda *s: torch.randn(*s, dtype=torch.bfloat16) * 0.05)(F, F))
    return {
        "x": _w((lambda *s: torch.randn(*s, dtype=torch.bfloat16) * 0.05)(B, S, D)),
        "qw": _w(qw),
        "scales": _w(torch.abs((lambda *s: torch.randn(*s, dtype=torch.bfloat16) * 0.05)(ng, F)) * 0.02 + 0.005),
        "zeros": _w(torch.full((ng, F), qmax / 2.0, dtype=float)),
        "U": _w(U.to(float)),
        "V": _w(V.to(float)),
    }

def reference(x, qw, scales, zeros, U, V):
    B, S, D = x.shape
    ng, F = scales.shape
    G = D // ng
    s = (lambda x, n, axis: torch.repeat_interleave(x, n, dim=axis))(scales, G, axis=0)
    z = (lambda x, n, axis: torch.repeat_interleave(x, n, dim=axis))(zeros, G, axis=0)
    wq = ((lambda x, dt: x.to(dt))(qw, x.dtype) - z) * s
    xr = torch.einsum("bsd,de->bse", x, U)
    h  = torch.einsum("bse,ef->bsf", xr, wq)
    y  = torch.einsum("bsf,fg->bsg", h, V)
    return y
```

```asm
; @launch grid=(256,1,1) block=(512,1,1) lds=62464
.amdgcn_target "amdgcn-amd-amdhsa--gfx950"
.text
.globl standalone__weight_only_int_quip__decode_kernel
.p2align 8
.type standalone__weight_only_int_quip__decode_kernel,@function
standalone__weight_only_int_quip__decode_kernel:
    s_load_dwordx16 s[4:19], s[0:1], 0
    s_load_dwordx2 s[20:21], s[0:1], 64
    s_getpc_b64 s[68:69]
    PC0:
    s_cmpk_ge_u32 s2, 256
    s_cbranch_scc1 END
    s_lshl4_add_u32 s77, s2, TABLE-PC0
    v_readfirstlane_b32 s59, v0
    v_and_b32 v2, 63, v0
    s_lshr_b32 s22, s2, 3
    s_and_b32 s23, s2, 7
    v_lshrrev_b32 v3, 4, v2
    v_and_b32 v4, 15, v2
    s_lshr_b32 s59, s59, 6
    s_cbranch_scc0 AUX
    s_lshl_b32 s60, s23, 3
    s_mov_b32 s62, 0x1a1a1f1f
    s_mov_b32 s63, 0xd0d0d09
    s_lshr_b64 s[62:63], s[62:63], s60
    s_and_b32 s62, s62, 0xff
    s_cmp_lt_u32 s22, s62
    s_cbranch_scc1 ROLE_XA
    s_load_dwordx4 s[64:67], s[68:69], s77
    s_sub_u32 s72, s59, 1
    s_mov_b64 vcc, -1
V_ENTRY:
    v_mul_u32_u24 v8, 73728, v3
    v_lshl_add_u32 v8, v4, 4, v8
    s_movk_i32 s45, 9216
    s_mov_b32 s26, 42467328
    s_mov_b32 s27, 0x00020000
    s_waitcnt lgkmcnt(0)
    s_and_b32 s60, s64, 7
    s_cmp_ge_u32 s72, s60
    s_cselect_b32 s44, s65, s64
    s_cselect_b32 s69, s67, s66
    s_cselect_b32 s60, s60, 0
    s_cselect_b32 s73, 16, 0
    s_sub_u32 s74, s72, s60
    s_and_b32 s75, s44, 7
    s_cmp_ge_u32 s74, s75
    s_cbranch_scc1 END
    s_and_b32 s44, s44, 0xffffff00
    s_mul_i32 s60, s74, 1179648
    s_add_u32 s44, s44, s60
    s_mov_b64 s[24:25], s[14:15]
    buffer_load_dwordx4 v[16:19], v8, s[24:27], s44 offen nt
    s_add_u32 s44, s44, s45
    buffer_load_dwordx4 v[20:23], v8, s[24:27], s44 offen nt
    s_add_u32 s44, s44, s45
    buffer_load_dwordx4 v[24:27], v8, s[24:27], s44 offen nt
    s_add_u32 s44, s44, s45
    buffer_load_dwordx4 v[28:31], v8, s[24:27], s44 offen nt
    s_branch V_MAIN
AUX:
    s_mov_b32 s70, CODE_END-PC0
    s_mov_b32 s71, 0x00020000
    v_lshlrev_b32 v1, 7, v2
    s_movk_i32 s42, 8192
    buffer_load_dword v244, v1, s[68:71], 0 offen offset:896
    buffer_load_dword v245, v1, s[68:71], s42 offen offset:896
    v_lshlrev_b32 v5, 2, v4
    v_mov_b32 v6, 0
    ds_write_b32 v5, v6 offset:36864
    s_cmp_ge_u32 s23, 2
    s_cbranch_scc1 AUXQ
    s_mul_i32 s42, s22, 20736
    s_lshl_b32 s43, s23, 9
    s_add_u32 s42, s42, s43
    v_mul_u32_u24 v5, 13, v2
    v_lshrrev_b32 v5, 6, v5
    v_lshl_add_u32 v5, v5, 9, v1
    s_mov_b32 s26, 663552
    s_mov_b32 s27, 0x00020000
    s_movk_i32 s70, 4608
    s_movk_i32 exec_hi, 0x1fff
    s_add_u32 s43, s42, 10368
    s_waitcnt lgkmcnt(0)
    s_mov_b64 s[24:25], s[12:13]
    s_mov_b64 s[68:69], s[4:5]
    buffer_load_dword v246, v1, s[68:71], 0 offen
    buffer_load_dword v247, v5, s[24:27], s42 offen
    buffer_load_dword v248, v5, s[24:27], s43 offen
    s_barrier
    s_branch AUX2
    AUXQ:
    v_mul_u32_u24 v6, 6144, v2
    s_mul_i32 s42, s22, 331776
    s_lshl_b32 s43, s23, 10
    s_add_u32 s42, s42, s43
    s_sub_u32 s42, s42, 1664
    s_mov_b32 s70, 10616832
    s_mov_b32 exec_hi, 0x3fffff
    s_waitcnt lgkmcnt(0)
    s_mov_b64 s[68:69], s[6:7]
    buffer_load_dword v7, v6, s[68:71], s42 offen
    s_barrier
    s_branch AUX2
ROLE_XA:
    s_cmp_ge_u32 s23, 2
    s_cbranch_scc1 ROLE_A
    s_cmp_ge_u32 s22, 9
    s_cbranch_scc1 ROLE_A
    s_cmp_eq_u32 s59, 7
    s_cbranch_scc1 X_W7
    s_sub_u32 s60, s59, 1
    v_lshrrev_b32 v5, 2, v4
    v_min_u32 v6, 2, v5
    v_and_b32 v7, 3, v4
    v_lshlrev_b32 v8, 5, v6
    v_lshl_add_u32 v8, v3, 3, v8
    v_mul_u32_u24 v9, 1152, v8
    v_lshl_add_u32 v9, v7, 4, v9
    s_mul_i32 s3, s23, 9
    s_add_u32 s3, s3, s22
    s_lshl_b32 s44, s3, 6
    s_mul_i32 s45, s60, 110592
    s_add_u32 s44, s44, s45
    s_add_u32 s47, s44, 4608
    v_mul_u32_u24 v10, 1152, v7
    v_lshl_add_u32 v10, v8, 1, v10
    s_mul_i32 s45, s60, 192
    s_mov_b32 s26, 663552
    s_mov_b32 s27, 0x00020000
    s_mov_b32 s34, 4608
    s_mov_b32 s35, 0x00020000
    s_waitcnt lgkmcnt(0)
    s_mov_b64 s[24:25], s[12:13]
    s_mov_b64 s[32:33], s[4:5]
    buffer_load_dwordx4 v[16:19], v9, s[24:27], s44 offen offset:0
    buffer_load_dwordx4 v[20:23], v9, s[24:27], s44 offen offset:1152
    buffer_load_dwordx4 v[24:27], v9, s[24:27], s44 offen offset:2304
    buffer_load_dwordx4 v[28:31], v9, s[24:27], s44 offen offset:3456
    buffer_load_dwordx4 v[32:35], v9, s[24:27], s47 offen offset:0
    buffer_load_dwordx4 v[36:39], v9, s[24:27], s47 offen offset:1152
    buffer_load_dwordx4 v[40:43], v9, s[24:27], s47 offen offset:2304
    buffer_load_dwordx4 v[44:47], v9, s[24:27], s47 offen offset:3456
    buffer_load_dwordx4 v[12:15], v10, s[32:35], s45 offen
    s_branch X_MAIN
ROLE_A:
    s_cmp_ge_u32 s59, 4
    s_cbranch_scc1 A_V
    s_mov_b32 s62, 0x442d11fb
    s_mov_b32 s63, 0x756b615b
    s_lshr_b64 s[62:63], s[62:63], s60
    s_add_u32 s62, s62, s22
    s_and_b32 s62, s62, 0xff
    s_mul_hi_u32 s61, s62, 613566757
    s_add_u32 s61, s62, s61
    s_sub_u32 s61, s61, 4
    s_mul_i32 s3, s22, 48
    s_add_u32 s3, s3, s60
    s_sub_u32 s3, s3, 13
    s_cmp_lt_u32 s22, 3
    s_cselect_b32 s3, s3, s61
    s_setprio 3
    s_sub_u32 s60, s59, 1
    v_lshrrev_b32 v5, 3, v4
    v_and_b32 v6, 7, v4
    v_lshl_add_u32 v7, v5, 2, v3
    v_mul_u32_u24 v7, 147456, v7
    v_lshl_add_u32 v7, v6, 4, v7
    s_mul_i32 s44, s60, 3538944
    s_lshl_b32 s45, s3, 7
    s_add_u32 s44, s44, s45
    s_movk_i32 s45, 18432
    s_mov_b32 s26, 10616832
    s_mov_b32 s27, 0x00020000
    s_waitcnt lgkmcnt(0)
    s_mov_b64 s[24:25], s[6:7]
    buffer_load_dwordx4 v[32:35], v7, s[24:27], s44 offen nt
    s_add_u32 s44, s44, s45
    buffer_load_dwordx4 v[36:39], v7, s[24:27], s44 offen nt
    s_add_u32 s44, s44, s45
    buffer_load_dwordx4 v[40:43], v7, s[24:27], s44 offen nt
    s_add_u32 s44, s44, s45
    buffer_load_dwordx4 v[44:47], v7, s[24:27], s44 offen nt
    s_add_u32 s44, s44, s45
    buffer_load_dwordx4 v[48:51], v7, s[24:27], s44 offen nt
    s_add_u32 s44, s44, s45
    buffer_load_dwordx4 v[52:55], v7, s[24:27], s44 offen nt
    s_add_u32 s44, s44, s45
    buffer_load_dwordx4 v[56:59], v7, s[24:27], s44 offen nt
    s_add_u32 s44, s44, s45
    buffer_load_dwordx4 v[60:63], v7, s[24:27], s44 offen nt
    s_add_u32 s44, s44, 1050624
    buffer_load_dwordx4 v[64:67], v7, s[24:27], s44 offen nt
    s_add_u32 s44, s44, s45
    buffer_load_dwordx4 v[68:71], v7, s[24:27], s44 offen nt
    s_add_u32 s44, s44, s45
FIRST_KB_END:
    s_load_dword s62, s[20:21], 0
    v_mul_u32_u24 v8, 9216, v5
    v_lshl_add_u32 v8, v6, 3, v8
    s_mul_i32 s46, s60, 55296
    s_lshl_b32 s47, s3, 6
    s_add_u32 s46, s46, s47
    s_mov_b64 s[32:33], s[8:9]
    s_mov_b32 s34, 165888
    s_mov_b32 s35, 0x00020000
    s_mov_b64 s[36:37], s[10:11]
    s_mov_b32 s38, 165888
    s_mov_b32 s39, 0x00020000
    buffer_load_dwordx2 v[16:17], v8, s[32:35], s46 offen
    buffer_load_dwordx2 v[18:19], v8, s[36:39], s46 offen
    s_add_u32 s46, s46, s45
    buffer_load_dwordx2 v[20:21], v8, s[32:35], s46 offen
    buffer_load_dwordx2 v[22:23], v8, s[36:39], s46 offen
    s_add_u32 s46, s46, s45
    buffer_load_dwordx2 v[24:25], v8, s[32:35], s46 offen
    buffer_load_dwordx2 v[26:27], v8, s[36:39], s46 offen
    buffer_load_dwordx4 v[72:75], v7, s[24:27], s44 offen nt
    s_add_u32 s44, s44, s45
    buffer_load_dwordx4 v[76:79], v7, s[24:27], s44 offen nt
    s_add_u32 s44, s44, s45
    buffer_load_dwordx4 v[80:83], v7, s[24:27], s44 offen nt
    s_add_u32 s44, s44, s45
    buffer_load_dwordx4 v[84:87], v7, s[24:27], s44 offen nt
    s_add_u32 s44, s44, s45
    buffer_load_dwordx4 v[88:91], v7, s[24:27], s44 offen nt
    s_add_u32 s44, s44, s45
    buffer_load_dwordx4 v[92:95], v7, s[24:27], s44 offen nt
    s_add_u32 s44, s44, 1050624
    buffer_load_dwordx4 v[96:99], v7, s[24:27], s44 offen nt
    s_add_u32 s44, s44, s45
    buffer_load_dwordx4 v[100:103], v7, s[24:27], s44 offen nt
    s_add_u32 s44, s44, s45
    buffer_load_dwordx4 v[104:107], v7, s[24:27], s44 offen nt
    s_add_u32 s44, s44, s45
    buffer_load_dwordx4 v[108:111], v7, s[24:27], s44 offen nt
    s_add_u32 s44, s44, s45
    buffer_load_dwordx4 v[112:115], v7, s[24:27], s44 offen nt
    s_add_u32 s44, s44, s45
    buffer_load_dwordx4 v[116:119], v7, s[24:27], s44 offen nt
    s_add_u32 s44, s44, s45
    buffer_load_dwordx4 v[120:123], v7, s[24:27], s44 offen nt
    s_add_u32 s44, s44, s45
    buffer_load_dwordx4 v[124:127], v7, s[24:27], s44 offen nt
    s_mov_b64 s[28:29], s[20:21]
    s_mov_b32 s30, 1605632
    s_mov_b32 s31, 0x00020000
    s_mov_b32 s46, 200000
    v_and_b32 v9, 3, v4
    v_mul_u32_u24 v9, 2304, v9
    v_lshl_add_u32 v9, v3, 5, v9
    v_lshrrev_b32 v10, 2, v4
    v_and_b32 v11, 1, v10
    v_lshl_add_u32 v11, v11, 7, v9
    v_lshl_add_u32 v9, v10, 7, v9
    s_mul_i32 s47, s60, 768
    s_add_u32 s47, s47, 4096
    v_lshlrev_b32 v12, 10, v5
    v_lshl_add_u32 v12, v6, 4, v12
    s_lshl_b32 s58, s60, 11
    v_add_u32 v12, s58, v12
    v_and_b32 v13, 1, v2
    v_lshlrev_b32 v13, 9, v13
    v_bfe_u32 v14, v2, 1, 3
    v_lshl_add_u32 v13, v14, 4, v13
    v_lshl_add_u32 v13, v3, 2, v13
    v_mul_u32_u24 v14, 18432, v3
    v_lshl_add_u32 v14, v4, 3, v14
    s_lshl_b32 s58, s3, 7
    s_add_u32 s58, s58, 16384
    s_lshl_b32 s61, s60, 2
    v_mov_b32 v15, s61
    s_waitcnt lgkmcnt(0)
    s_and_b32 s61, s62, 0x7f7f7f7f
    s_add_u32 s61, s61, 0x01010101
    s_and_b32 s62, s62, 0x80808080
    s_xor_b32 s62, s62, s61
    s_waitcnt vmcnt(18)
    v_lshlrev_b32 v128, 16, v16
    v_lshlrev_b32 v132, 16, v18
    v_mul_f32_e64 v132, -v132, v128
    v_and_b32 v129, 0xffff0000, v16
    v_and_b32 v133, 0xffff0000, v18
    v_mul_f32_e64 v133, -v133, v129
    v_lshlrev_b32 v130, 16, v17
    v_lshlrev_b32 v134, 16, v19
    v_mul_f32_e64 v134, -v134, v130
    v_and_b32 v131, 0xffff0000, v17
    v_and_b32 v135, 0xffff0000, v19
    v_mul_f32_e64 v135, -v135, v131
    v_cvt_f32_i32 v32, v32
    v_cvt_f32_i32 v33, v33
    v_cvt_f32_i32 v34, v34
    v_cvt_f32_i32 v35, v35
    v_pk_fma_f32 v[32:33], v[32:33], v[128:129], v[132:133]
    v_pk_fma_f32 v[34:35], v[34:35], v[130:131], v[134:135]
    v_cvt_f32_i32 v36, v36
    v_cvt_f32_i32 v37, v37
    v_cvt_f32_i32 v38, v38
    v_cvt_f32_i32 v39, v39
    v_pk_fma_f32 v[36:37], v[36:37], v[128:129], v[132:133]
    v_pk_fma_f32 v[38:39], v[38:39], v[130:131], v[134:135]
    v_cvt_pk_bf16_f32 v144, v32, v36
    v_cvt_pk_bf16_f32 v148, v33, v37
    v_cvt_pk_bf16_f32 v152, v34, v38
    v_cvt_pk_bf16_f32 v156, v35, v39
    v_cvt_f32_i32 v40, v40
    v_cvt_f32_i32 v41, v41
    v_cvt_f32_i32 v42, v42
    v_cvt_f32_i32 v43, v43
    v_pk_fma_f32 v[40:41], v[40:41], v[128:129], v[132:133]
    v_pk_fma_f32 v[42:43], v[42:43], v[130:131], v[134:135]
    v_cvt_f32_i32 v44, v44
    v_cvt_f32_i32 v45, v45
    v_cvt_f32_i32 v46, v46
    v_cvt_f32_i32 v47, v47
    v_pk_fma_f32 v[44:45], v[44:45], v[128:129], v[132:133]
    v_pk_fma_f32 v[46:47], v[46:47], v[130:131], v[134:135]
    v_cvt_pk_bf16_f32 v145, v40, v44
    v_cvt_pk_bf16_f32 v149, v41, v45
    v_cvt_pk_bf16_f32 v153, v42, v46
    v_cvt_pk_bf16_f32 v157, v43, v47
    v_cvt_f32_i32 v48, v48
    v_cvt_f32_i32 v49, v49
    v_cvt_f32_i32 v50, v50
    v_cvt_f32_i32 v51, v51
    v_pk_fma_f32 v[48:49], v[48:49], v[128:129], v[132:133]
    v_pk_fma_f32 v[50:51], v[50:51], v[130:131], v[134:135]
    v_cvt_f32_i32 v52, v52
    v_cvt_f32_i32 v53, v53
    v_cvt_f32_i32 v54, v54
    v_cvt_f32_i32 v55, v55
    v_pk_fma_f32 v[52:53], v[52:53], v[128:129], v[132:133]
    v_pk_fma_f32 v[54:55], v[54:55], v[130:131], v[134:135]
    v_cvt_pk_bf16_f32 v146, v48, v52
    v_cvt_pk_bf16_f32 v150, v49, v53
    v_cvt_pk_bf16_f32 v154, v50, v54
    v_cvt_pk_bf16_f32 v158, v51, v55
    v_cvt_f32_i32 v56, v56
    v_cvt_f32_i32 v57, v57
    v_cvt_f32_i32 v58, v58
    v_cvt_f32_i32 v59, v59
    v_pk_fma_f32 v[56:57], v[56:57], v[128:129], v[132:133]
    v_pk_fma_f32 v[58:59], v[58:59], v[130:131], v[134:135]
    v_cvt_f32_i32 v60, v60
    v_cvt_f32_i32 v61, v61
    v_cvt_f32_i32 v62, v62
    v_cvt_f32_i32 v63, v63
    v_pk_fma_f32 v[60:61], v[60:61], v[128:129], v[132:133]
    v_pk_fma_f32 v[62:63], v[62:63], v[130:131], v[134:135]
    v_cvt_pk_bf16_f32 v147, v56, v60
    v_cvt_pk_bf16_f32 v151, v57, v61
    v_cvt_pk_bf16_f32 v155, v58, v62
    v_cvt_pk_bf16_f32 v159, v59, v63
    s_waitcnt vmcnt(16)
    v_lshlrev_b32 v128, 16, v20
    v_lshlrev_b32 v132, 16, v22
    v_mul_f32_e64 v132, -v132, v128
    v_and_b32 v129, 0xffff0000, v20
    v_and_b32 v133, 0xffff0000, v22
    v_mul_f32_e64 v133, -v133, v129
    v_lshlrev_b32 v130, 16, v21
    v_lshlrev_b32 v134, 16, v23
    v_mul_f32_e64 v134, -v134, v130
    v_and_b32 v131, 0xffff0000, v21
    v_and_b32 v135, 0xffff0000, v23
    v_mul_f32_e64 v135, -v135, v131
    v_cvt_f32_i32 v64, v64
    v_cvt_f32_i32 v65, v65
    v_cvt_f32_i32 v66, v66
    v_cvt_f32_i32 v67, v67
    v_pk_fma_f32 v[64:65], v[64:65], v[128:129], v[132:133]
    v_pk_fma_f32 v[66:67], v[66:67], v[130:131], v[134:135]
    v_cvt_f32_i32 v68, v68
    v_cvt_f32_i32 v69, v69
    v_cvt_f32_i32 v70, v70
    v_cvt_f32_i32 v71, v71
    v_pk_fma_f32 v[68:69], v[68:69], v[128:129], v[132:133]
    v_pk_fma_f32 v[70:71], v[70:71], v[130:131], v[134:135]
    v_cvt_pk_bf16_f32 v160, v64, v68
    v_cvt_pk_bf16_f32 v164, v65, v69
    v_cvt_pk_bf16_f32 v168, v66, v70
    v_cvt_pk_bf16_f32 v172, v67, v71
    s_waitcnt vmcnt(12)
    v_cvt_f32_i32 v72, v72
    v_cvt_f32_i32 v73, v73
    v_cvt_f32_i32 v74, v74
    v_cvt_f32_i32 v75, v75
    v_pk_fma_f32 v[72:73], v[72:73], v[128:129], v[132:133]
    v_pk_fma_f32 v[74:75], v[74:75], v[130:131], v[134:135]
    v_cvt_f32_i32 v76, v76
    v_cvt_f32_i32 v77, v77
    v_cvt_f32_i32 v78, v78
    v_cvt_f32_i32 v79, v79
    v_pk_fma_f32 v[76:77], v[76:77], v[128:129], v[132:133]
    v_pk_fma_f32 v[78:79], v[78:79], v[130:131], v[134:135]
    v_cvt_pk_bf16_f32 v161, v72, v76
    v_cvt_pk_bf16_f32 v165, v73, v77
    v_cvt_pk_bf16_f32 v169, v74, v78
    v_cvt_pk_bf16_f32 v173, v75, v79
    s_waitcnt vmcnt(10)
    v_cvt_f32_i32 v80, v80
    v_cvt_f32_i32 v81, v81
    v_cvt_f32_i32 v82, v82
    v_cvt_f32_i32 v83, v83
    v_pk_fma_f32 v[80:81], v[80:81], v[128:129], v[132:133]
    v_pk_fma_f32 v[82:83], v[82:83], v[130:131], v[134:135]
    v_cvt_f32_i32 v84, v84
    v_cvt_f32_i32 v85, v85
    v_cvt_f32_i32 v86, v86
    v_cvt_f32_i32 v87, v87
    v_pk_fma_f32 v[84:85], v[84:85], v[128:129], v[132:133]
    v_pk_fma_f32 v[86:87], v[86:87], v[130:131], v[134:135]
    v_cvt_pk_bf16_f32 v162, v80, v84
    v_cvt_pk_bf16_f32 v166, v81, v85
    v_cvt_pk_bf16_f32 v170, v82, v86
    v_cvt_pk_bf16_f32 v174, v83, v87
    s_waitcnt vmcnt(8)
    v_cvt_f32_i32 v88, v88
    v_cvt_f32_i32 v89, v89
    v_cvt_f32_i32 v90, v90
    v_cvt_f32_i32 v91, v91
    v_pk_fma_f32 v[88:89], v[88:89], v[128:129], v[132:133]
    v_pk_fma_f32 v[90:91], v[90:91], v[130:131], v[134:135]
    v_cvt_f32_i32 v92, v92
    v_cvt_f32_i32 v93, v93
    v_cvt_f32_i32 v94, v94
    v_cvt_f32_i32 v95, v95
    v_pk_fma_f32 v[92:93], v[92:93], v[128:129], v[132:133]
    v_pk_fma_f32 v[94:95], v[94:95], v[130:131], v[134:135]
    v_cvt_pk_bf16_f32 v163, v88, v92
    v_cvt_pk_bf16_f32 v167, v89, v93
    v_cvt_pk_bf16_f32 v171, v90, v94
    v_cvt_pk_bf16_f32 v175, v91, v95
    v_lshlrev_b32 v128, 16, v24
    v_lshlrev_b32 v132, 16, v26
    v_mul_f32_e64 v132, -v132, v128
    v_and_b32 v129, 0xffff0000, v24
    v_and_b32 v133, 0xffff0000, v26
    v_mul_f32_e64 v133, -v133, v129
    v_lshlrev_b32 v130, 16, v25
    v_lshlrev_b32 v134, 16, v27
    v_mul_f32_e64 v134, -v134, v130
    v_and_b32 v131, 0xffff0000, v25
    v_and_b32 v135, 0xffff0000, v27
    v_mul_f32_e64 v135, -v135, v131
    s_waitcnt vmcnt(6)
    v_cvt_f32_i32 v96, v96
    v_cvt_f32_i32 v97, v97
    v_cvt_f32_i32 v98, v98
    v_cvt_f32_i32 v99, v99
    v_pk_fma_f32 v[96:97], v[96:97], v[128:129], v[132:133]
    v_pk_fma_f32 v[98:99], v[98:99], v[130:131], v[134:135]
    v_cvt_f32_i32 v100, v100
    v_cvt_f32_i32 v101, v101
    v_cvt_f32_i32 v102, v102
    v_cvt_f32_i32 v103, v103
    v_pk_fma_f32 v[100:101], v[100:101], v[128:129], v[132:133]
    v_pk_fma_f32 v[102:103], v[102:103], v[130:131], v[134:135]
    v_cvt_pk_bf16_f32 v176, v96, v100
    v_cvt_pk_bf16_f32 v180, v97, v101
    v_cvt_pk_bf16_f32 v184, v98, v102
    v_cvt_pk_bf16_f32 v188, v99, v103
    s_waitcnt vmcnt(4)
    v_cvt_f32_i32 v104, v104
    v_cvt_f32_i32 v105, v105
    v_cvt_f32_i32 v106, v106
    v_cvt_f32_i32 v107, v107
    v_pk_fma_f32 v[104:105], v[104:105], v[128:129], v[132:133]
    v_pk_fma_f32 v[106:107], v[106:107], v[130:131], v[134:135]
    v_cvt_f32_i32 v108, v108
    v_cvt_f32_i32 v109, v109
    v_cvt_f32_i32 v110, v110
    v_cvt_f32_i32 v111, v111
    v_pk_fma_f32 v[108:109], v[108:109], v[128:129], v[132:133]
    v_pk_fma_f32 v[110:111], v[110:111], v[130:131], v[134:135]
    v_cvt_pk_bf16_f32 v177, v104, v108
    v_cvt_pk_bf16_f32 v181, v105, v109
    v_cvt_pk_bf16_f32 v185, v106, v110
    v_cvt_pk_bf16_f32 v189, v107, v111
    buffer_load_dwordx4 v[208:211], v9, s[28:31], s47 offen sc1
    buffer_load_dwordx4 v[212:215], v9, s[28:31], s47 offen offset:16 sc1
    buffer_load_dwordx4 v[216:219], v11, s[28:31], s47 offen offset:512 sc1
    buffer_load_dwordx4 v[220:223], v11, s[28:31], s47 offen offset:528 sc1
    s_barrier
    s_waitcnt vmcnt(6)
    v_cvt_f32_i32 v112, v112
    v_cvt_f32_i32 v113, v113
    v_cvt_f32_i32 v114, v114
    v_cvt_f32_i32 v115, v115
    v_pk_fma_f32 v[112:113], v[112:113], v[128:129], v[132:133]
    v_pk_fma_f32 v[114:115], v[114:115], v[130:131], v[134:135]
    v_cvt_f32_i32 v116, v116
    v_cvt_f32_i32 v117, v117
    v_cvt_f32_i32 v118, v118
    v_cvt_f32_i32 v119, v119
    v_pk_fma_f32 v[116:117], v[116:117], v[128:129], v[132:133]
    v_pk_fma_f32 v[118:119], v[118:119], v[130:131], v[134:135]
    v_cvt_pk_bf16_f32 v178, v112, v116
    v_cvt_pk_bf16_f32 v182, v113, v117
    v_cvt_pk_bf16_f32 v186, v114, v118
    v_cvt_pk_bf16_f32 v190, v115, v119
    s_waitcnt vmcnt(4)
    v_cvt_f32_i32 v120, v120
    v_cvt_f32_i32 v121, v121
    v_cvt_f32_i32 v122, v122
    v_cvt_f32_i32 v123, v123
    v_pk_fma_f32 v[120:121], v[120:121], v[128:129], v[132:133]
    v_pk_fma_f32 v[122:123], v[122:123], v[130:131], v[134:135]
    v_cvt_f32_i32 v124, v124
    v_cvt_f32_i32 v125, v125
    v_cvt_f32_i32 v126, v126
    v_cvt_f32_i32 v127, v127
    v_pk_fma_f32 v[124:125], v[124:125], v[128:129], v[132:133]
    v_pk_fma_f32 v[126:127], v[126:127], v[130:131], v[134:135]
    v_cvt_pk_bf16_f32 v179, v120, v124
    v_cvt_pk_bf16_f32 v183, v121, v125
    v_cvt_pk_bf16_f32 v187, v122, v126
    v_cvt_pk_bf16_f32 v191, v123, v127
    s_waitcnt vmcnt(0)
    v_cmp_ne_u32 s[48:49], v209, s62
    v_cmp_ne_u32 s[50:51], v211, s62
    v_cmp_ne_u32 s[52:53], v213, s62
    v_cmp_ne_u32 s[54:55], v215, s62
    s_or_b64 s[48:49], s[48:49], s[50:51]
    s_or_b64 s[52:53], s[52:53], s[54:55]
    s_or_b64 s[56:57], s[48:49], s[52:53]
    v_cmp_ne_u32 s[48:49], v217, s62
    s_or_b64 s[56:57], s[56:57], s[48:49]
    v_cmp_ne_u32 s[50:51], v219, s62
    s_or_b64 s[56:57], s[56:57], s[50:51]
    v_cmp_ne_u32 s[52:53], v221, s62
    s_or_b64 s[56:57], s[56:57], s[52:53]
    v_cmp_ne_u32 s[54:55], v223, s62
    s_or_b64 s[56:57], s[56:57], s[54:55]
    s_cbranch_scc1 H_RETRY
H_GOT:
    v_mov_b32 v224, v208
    v_mov_b32_dpp v228, v208 row_shl:8 row_mask:0xf bank_mask:0xf bound_ctrl:0
    v_mov_b32 v232, v216
    v_mov_b32 v225, v210
    v_mov_b32_dpp v229, v210 row_shl:8 row_mask:0xf bank_mask:0xf bound_ctrl:0
    v_mov_b32 v233, v218
    v_mov_b32 v226, v212
    v_mov_b32_dpp v230, v212 row_shl:8 row_mask:0xf bank_mask:0xf bound_ctrl:0
    v_mov_b32 v234, v220
    v_mov_b32 v227, v214
    v_mov_b32_dpp v231, v214 row_shl:8 row_mask:0xf bank_mask:0xf bound_ctrl:0
    v_mov_b32 v235, v222
    s_nop 1
    v_mfma_f32_16x16x32_bf16 v[192:195], v[224:227], v[144:147], 0
    v_mfma_f32_16x16x32_bf16 v[196:199], v[224:227], v[148:151], 0
    v_mfma_f32_16x16x32_bf16 v[200:203], v[224:227], v[152:155], 0
    v_mfma_f32_16x16x32_bf16 v[204:207], v[224:227], v[156:159], 0
    v_mfma_f32_16x16x32_bf16 v[192:195], v[228:231], v[160:163], v[192:195]
    v_mfma_f32_16x16x32_bf16 v[196:199], v[228:231], v[164:167], v[196:199]
    v_mfma_f32_16x16x32_bf16 v[200:203], v[228:231], v[168:171], v[200:203]
    v_mfma_f32_16x16x32_bf16 v[204:207], v[228:231], v[172:175], v[204:207]
    v_mfma_f32_16x16x32_bf16 v[192:195], v[232:235], v[176:179], v[192:195]
    v_mfma_f32_16x16x32_bf16 v[196:199], v[232:235], v[180:183], v[196:199]
    v_mfma_f32_16x16x32_bf16 v[200:203], v[232:235], v[184:187], v[200:203]
    v_mfma_f32_16x16x32_bf16 v[204:207], v[232:235], v[188:191], v[204:207]
    v_mov_b32 v16, 1
    v_mov_b32 v17, 36864
    s_mov_b32 exec_lo, 0xff0000ff
    s_mov_b32 exec_hi, 0
    s_nop 1
    ds_write_b128 v12, v[192:195] offset:0
    ds_write_b128 v12, v[196:199] offset:256
    ds_write_b128 v12, v[200:203] offset:512
    ds_write_b128 v12, v[204:207] offset:768
    s_cmp_eq_u32 s60, 0
    s_cbranch_scc1 H_SPIN0
    ds_write_b32 v15, v16 offset:36896
    s_cmp_lt_u32 s23, 4
    s_cbranch_scc1 H_END
    s_cmp_ge_u32 s22, 4
    s_cbranch_scc1 H_END
    s_setprio 0
    s_lshl1_add_u32 s22, s22, s60
    s_add_u32 s22, s22, 31
    s_branch AUX2
H_END:
    s_endpgm
H_SPIN0:
    s_mov_b64 exec, -1
H_SPIN:
    ds_read2_b32 v[18:19], v17 offset0:9 offset1:10
    ds_read2st64_b32 v[20:21], v13 offset0:0 offset1:1
    ds_read2st64_b32 v[22:23], v13 offset0:4 offset1:5
    ds_read2st64_b32 v[24:25], v13 offset0:8 offset1:9
    ds_read2st64_b32 v[26:27], v13 offset0:12 offset1:13
    ds_read2st64_b32 v[28:29], v13 offset0:16 offset1:17
    ds_read2st64_b32 v[30:31], v13 offset0:20 offset1:21
    s_waitcnt lgkmcnt(0)
    v_and_b32 v18, v18, v19
    v_cmp_ne_u32 vcc, 1, v18
    s_cbranch_vccz H_RDY
    s_sub_u32 s46, s46, 1
    s_cmp_lg_u32 s46, 0
    s_cbranch_scc1 H_SPIN
H_RDY:
    v_pk_add_f32 v[20:21], v[20:21], v[22:23]
    v_pk_add_f32 v[24:25], v[24:25], v[26:27]
    v_pk_add_f32 v[28:29], v[28:29], v[30:31]
    v_pk_add_f32 v[20:21], v[20:21], v[24:25]
    v_pk_add_f32 v[20:21], v[20:21], v[28:29]
    v_cvt_pk_bf16_f32 v20, v20, v21
    v_mov_b32 v21, s62
    buffer_store_dwordx2 v[20:21], v14, s[28:31], s58 offen sc1
    s_endpgm
H_RETRY:
    s_sleep 1
    buffer_load_dwordx4 v[208:211], v9, s[28:31], s47 offen sc1
    buffer_load_dwordx4 v[212:215], v9, s[28:31], s47 offen offset:16 sc1
    buffer_load_dwordx4 v[216:219], v11, s[28:31], s47 offen offset:512 sc1
    buffer_load_dwordx4 v[220:223], v11, s[28:31], s47 offen offset:528 sc1
    s_waitcnt vmcnt(0)
    v_cmp_ne_u32 s[48:49], v209, s62
    v_cmp_ne_u32 s[50:51], v211, s62
    v_cmp_ne_u32 s[52:53], v213, s62
    v_cmp_ne_u32 s[54:55], v215, s62
    s_or_b64 s[48:49], s[48:49], s[50:51]
    s_or_b64 s[52:53], s[52:53], s[54:55]
    s_or_b64 s[56:57], s[48:49], s[52:53]
    v_cmp_ne_u32 s[48:49], v217, s62
    s_or_b64 s[56:57], s[56:57], s[48:49]
    v_cmp_ne_u32 s[50:51], v219, s62
    s_or_b64 s[56:57], s[56:57], s[50:51]
    v_cmp_ne_u32 s[52:53], v221, s62
    s_or_b64 s[56:57], s[56:57], s[52:53]
    v_cmp_ne_u32 s[54:55], v223, s62
    s_or_b64 s[56:57], s[56:57], s[54:55]
    s_cbranch_scc0 H_GOT
    s_sub_u32 s46, s46, 1
    s_cmp_lg_u32 s46, 0
    s_cbranch_scc1 H_RETRY
    s_branch H_GOT
AUX2:
    s_getpc_b64 s[78:79]
    PC1:
    s_lshl4_add_u32 s77, s2, TABLE-PC1
    s_load_dwordx4 s[64:67], s[78:79], s77
    s_mov_b64 exec, -1
    s_cmp_ge_u32 s23, 2
    s_cbranch_scc1 AUX3
    s_cmp_ge_u32 s22, 9
    s_cbranch_scc1 AUX3
    s_barrier
    AUX3:
    s_lshr_b32 s42, s22, 3
    s_lshl2_add_u32 s43, s23, s42
    s_and_b32 s61, s22, 7
    s_movk_i32 s45, 8192
    s_mov_b32 s46, 200000
    v_mov_b32 v17, 36864
    v_lshlrev_b32 v14, 11, v3
    v_lshl_add_u32 v14, v4, 4, v14
    v_mul_u32_u24 v15, 9216, v3
    v_and_b32 v12, 3, v4
    v_lshl_add_u32 v15, v12, 4, v15
    v_lshrrev_b32 v12, 2, v4
    v_lshl_add_u32 v15, v12, 1, v15
    v_and_b32 v12, 1, v2
    v_lshrrev_b32 v13, 1, v2
    v_lshlrev_b32 v13, 11, v13
    v_lshl_add_u32 v13, v12, 7, v13
    s_getreg_b32 s76, hwreg(HW_REG_XCC_ID, 0, 4)
    s_lshl_b32 s76, s76, 8
    s_waitcnt lgkmcnt(0)
    s_bfe_u32 s75, s66, 0x50006
    s_cmp_lt_u32 s22, 32
    s_cbranch_scc1 AUX4
    s_bfe_u32 s75, s67, 0x50006
    s_bfe_u32 s43, s65, 0x20003
    s_add_u32 s43, s43, 32
    AUX4:
    s_mul_i32 s68, s43, 40960
    s_lshl_b32 s60, s61, 8
    s_add_u32 s68, s68, s60
    s_add_u32 s68, s68, 131072
    s_lshr_b32 s60, s61, 1
    s_lshl2_add_u32 s72, s43, s60
    s_lshl_b32 s72, s72, 6
    s_and_b32 s60, s61, 1
    s_lshl3_add_u32 s72, s60, s72
    s_lshl_b32 s60, s75, 11
    s_add_u32 s30, s68, s60
    s_sub_u32 s30, s30, 1792
    s_mov_b32 s31, 0x00020000
    s_lshl_b32 s60, s43, 7
    s_lshl2_add_u32 s60, s61, s60
    s_add_u32 s60, s60, 98304
    v_mov_b32 v10, s60
    s_mov_b64 s[28:29], s[20:21]
    s_mov_b64 s[32:33], s[16:17]
    s_mov_b32 s34, 36864
    s_mov_b32 s35, 0x00020000
    s_mov_b64 s[36:37], s[18:19]
    s_mov_b32 s38, 256
    s_mov_b32 s39, 0x00020000
    v_mov_b32 v11, 0
    buffer_load_dword v21, v13, s[28:31], s68 offen
    s_cmpk_eq_u32 s2, 255
    s_cbranch_scc1 RELAY
G_TAG:
    buffer_load_dwordx2 v[18:19], v11, s[36:39], 0 offen sc1
    s_waitcnt vmcnt(0)
    v_cmp_ne_u32 vcc, 1, v19
    s_cbranch_vccz G_TAG_OK
    s_sleep 24
    s_sub_u32 s46, s46, 1
    s_cmp_lg_u32 s46, 0
    s_cbranch_scc1 G_TAG
G_TAG_OK:
    v_xor_b32 v9, s76, v18
    s_mov_b64 exec, 1
    buffer_store_dword v9, v10, s[28:31], 0 offen sc1
    s_mov_b64 exec, -1
    v_and_b32 v24, 0xff, v18
    v_bfe_u32 v25, v18, 8, 8
    v_bfe_u32 v26, v18, 16, 8
    v_lshrrev_b32 v27, 24, v18
    v_add_u32 v12, 8, v3
    v_cmp_gt_u32 vcc, s75, v12
    s_nop 1
    v_cndmask_b32 v64, 0, v24, vcc
    v_cndmask_b32 v65, 0, v25, vcc
    v_cndmask_b32 v66, 0, v26, vcc
    v_cndmask_b32 v67, 0, v27, vcc
    v_add_u32 v12, 12, v3
    v_cmp_gt_u32 vcc, s75, v12
    s_nop 1
    v_cndmask_b32 v68, 0, v24, vcc
    v_cndmask_b32 v69, 0, v25, vcc
    v_cndmask_b32 v70, 0, v26, vcc
    v_cndmask_b32 v71, 0, v27, vcc
    v_add_u32 v12, 16, v3
    v_cmp_gt_u32 vcc, s75, v12
    s_nop 1
    v_cndmask_b32 v72, 0, v24, vcc
    v_cndmask_b32 v73, 0, v25, vcc
    v_cndmask_b32 v74, 0, v26, vcc
    v_cndmask_b32 v75, 0, v27, vcc
G_WAIT:
    s_sleep 2
    ds_read_b32 v19, v17 offset:48
    s_waitcnt lgkmcnt(0)
    v_cmp_ne_u32 vcc, 1, v19
    s_cbranch_vccz G_GO
    s_sub_u32 s46, s46, 1
    s_cmp_lg_u32 s46, 0
    s_cbranch_scc1 G_WAIT
G_GO:
G_POLL:
    s_mov_b32 s70, s68
    buffer_load_dwordx4 v[32:35], v14, s[28:31], s70 offen sc1
    s_add_u32 s70, s70, s45
    buffer_load_dwordx4 v[36:39], v14, s[28:31], s70 offen sc1
    s_add_u32 s70, s70, s45
    buffer_load_dwordx4 v[40:43], v14, s[28:31], s70 offen sc1
    s_add_u32 s70, s70, s45
    buffer_load_dwordx4 v[44:47], v14, s[28:31], s70 offen sc1
    s_add_u32 s70, s70, s45
    buffer_load_dwordx4 v[48:51], v14, s[28:31], s70 offen sc1
    s_waitcnt vmcnt(4)
    v_xor_b32 v32, v32, v24
    v_xor_b32 v33, v33, v25
    v_xor_b32 v34, v34, v26
    v_xor_b32 v35, v35, v27
    v_or3_b32 v16, v32, v33, v34
    v_or_b32 v16, v16, v35
    s_waitcnt vmcnt(3)
    v_xor_b32 v36, v36, v24
    v_xor_b32 v37, v37, v25
    v_xor_b32 v38, v38, v26
    v_xor_b32 v39, v39, v27
    v_or3_b32 v16, v16, v36, v37
    v_or3_b32 v16, v16, v38, v39
    v_pk_add_f32 v[32:33], v[32:33], v[36:37]
    v_pk_add_f32 v[34:35], v[34:35], v[38:39]
    s_waitcnt vmcnt(2)
    v_xor_b32 v40, v40, v64
    v_xor_b32 v41, v41, v65
    v_xor_b32 v42, v42, v66
    v_xor_b32 v43, v43, v67
    v_or3_b32 v16, v16, v40, v41
    v_or3_b32 v16, v16, v42, v43
    v_pk_add_f32 v[32:33], v[32:33], v[40:41]
    v_pk_add_f32 v[34:35], v[34:35], v[42:43]
    s_waitcnt vmcnt(1)
    v_xor_b32 v44, v44, v68
    v_xor_b32 v45, v45, v69
    v_xor_b32 v46, v46, v70
    v_xor_b32 v47, v47, v71
    v_or3_b32 v16, v16, v44, v45
    v_or3_b32 v16, v16, v46, v47
    v_pk_add_f32 v[32:33], v[32:33], v[44:45]
    v_pk_add_f32 v[34:35], v[34:35], v[46:47]
    s_waitcnt vmcnt(0)
    v_xor_b32 v48, v48, v72
    v_xor_b32 v49, v49, v73
    v_xor_b32 v50, v50, v74
    v_xor_b32 v51, v51, v75
    v_or3_b32 v16, v16, v48, v49
    v_or3_b32 v16, v16, v50, v51
    v_pk_add_f32 v[32:33], v[32:33], v[48:49]
    v_pk_add_f32 v[34:35], v[34:35], v[50:51]
    v_and_b32 v16, 0xff, v16
    v_cmp_ne_u32 vcc, 0, v16
    s_cbranch_vccnz G_AGAIN
G_OK:
    v_permlane16_swap_b32 v32, v33
    v_permlane16_swap_b32 v34, v35
    s_nop 0
    v_add_f32 v32, v32, v33
    v_add_f32 v34, v34, v35
    s_nop 1
    v_permlane32_swap_b32 v32, v34
    s_nop 0
    v_add_f32 v32, v32, v34
    v_cvt_pk_bf16_f32 v32, v32, v32
    buffer_store_short v32, v15, s[32:35], s72 offen
    s_cmp_lg_u32 s72, 0
    s_cbranch_scc1 G_FIN
    s_mov_b64 exec, 1
    buffer_store_dword v18, v11, s[28:31], 0 offen sc1
G_FIN:
    s_endpgm
G_AGAIN:
    s_sub_u32 s46, s46, 1
    s_cmp_lg_u32 s46, 0
    s_cbranch_scc1 G_POLL
    s_branch G_OK
V_MAIN:
    s_cbranch_vccz V_NOBAR
    s_barrier
V_NOBAR:
    s_mov_b64 s[28:29], s[20:21]
    s_mov_b32 s30, 1605632
    s_mov_b32 s31, 0x00020000
    s_mov_b64 s[36:37], s[18:19]
    s_mov_b32 s38, 256
    s_mov_b32 s39, 0x00020000
    s_mov_b32 s40, 0x05040100
    s_mov_b32 s41, 0x07060302
    s_mov_b32 s46, 200000
    v_and_b32 v5, 3, v4
    v_mul_u32_u24 v9, 18432, v5
    v_lshrrev_b32 v12, 2, v4
    v_lshl_add_u32 v9, v12, 7, v9
    v_lshl_add_u32 v9, v3, 5, v9
    v_lshlrev_b32 v13, 9, v12
    v_lshl_add_u32 v13, v3, 6, v13
    v_lshl_add_u32 v13, v5, 4, v13
    v_mov_b32 v12, 0
    s_and_b32 s47, s69, 63
    s_add_u32 s47, s47, s74
    s_lshl_b32 s47, s47, 9
    s_add_u32 s47, s47, 16384
    s_lshr_b32 s68, s69, 24
    s_lshl_b32 s68, s68, 5
    s_add_u32 s68, s68, 98304
    s_and_b32 s69, s69, 0xfff800
    s_getreg_b32 s76, hwreg(HW_REG_XCC_ID, 0, 4)
    s_lshl_b32 s76, s76, 8
    s_movk_i32 s71, 0xff
    s_lshl_b32 s70, s72, 11
    v_lshl_add_u32 v14, v2, 4, s70
    v_mov_b32 v7, 1
    v_mov_b32 v15, s73
    s_sub_u32 s75, s75, 1
    v_mov_b32 v192, 0
    v_mov_b32 v193, 0
    v_mov_b32 v194, 0
    v_mov_b32 v195, 0
    v_mov_b32 v196, 0
    v_mov_b32 v197, 0
    v_mov_b32 v198, 0
    v_mov_b32 v199, 0
    v_mov_b32 v200, 0
    v_mov_b32 v201, 0
    v_mov_b32 v202, 0
    v_mov_b32 v203, 0
    v_mov_b32 v204, 0
    v_mov_b32 v205, 0
    v_mov_b32 v206, 0
    v_mov_b32 v207, 0
    v_mov_b32 v208, 0
    v_mov_b32 v209, 0
    v_mov_b32 v210, 0
    v_mov_b32 v211, 0
    v_mov_b32 v212, 0
    v_mov_b32 v213, 0
    v_mov_b32 v214, 0
    v_mov_b32 v215, 0
    v_mov_b32 v216, 0
    v_mov_b32 v217, 0
    v_mov_b32 v218, 0
    v_mov_b32 v219, 0
    v_mov_b32 v220, 0
    v_mov_b32 v221, 0
    v_mov_b32 v222, 0
    v_mov_b32 v223, 0
    s_add_u32 s44, s44, s45
    s_cbranch_vccz VD4
    s_waitcnt vmcnt(3)
VD4:
    buffer_load_dwordx4 v[32:35], v8, s[24:27], s44 offen nt
    s_add_u32 s44, s44, s45
    s_cbranch_vccz VD5
    s_waitcnt vmcnt(3)
VD5:
    buffer_load_dwordx4 v[36:39], v8, s[24:27], s44 offen nt
    s_waitcnt vmcnt(5)
    s_add_u32 s44, s44, s45
    s_cbranch_vccz VD6
    s_waitcnt vmcnt(3)
VD6:
    buffer_load_dwordx4 v[40:43], v8, s[24:27], s44 offen nt
    s_waitcnt vmcnt(5)
    s_add_u32 s44, s44, s45
    s_cbranch_vccz VD7
    s_waitcnt vmcnt(3)
VD7:
    buffer_load_dwordx4 v[44:47], v8, s[24:27], s44 offen nt
    v_perm_b32 v64, v20, v16, s40
    v_perm_b32 v68, v20, v16, s41
    v_perm_b32 v72, v21, v17, s40
    v_perm_b32 v76, v21, v17, s41
    v_perm_b32 v80, v22, v18, s40
    v_perm_b32 v84, v22, v18, s41
    v_perm_b32 v88, v23, v19, s40
    v_perm_b32 v92, v23, v19, s41
    s_waitcnt vmcnt(5)
    s_add_u32 s44, s44, 230400
    s_cbranch_vccz VD8
    s_waitcnt vmcnt(3)
VD8:
    buffer_load_dwordx4 v[16:19], v8, s[24:27], s44 offen nt
    s_waitcnt vmcnt(5)
    s_add_u32 s44, s44, s45
    s_cbranch_vccz VD9
    s_waitcnt vmcnt(3)
VD9:
    buffer_load_dwordx4 v[20:23], v8, s[24:27], s44 offen nt
    v_perm_b32 v65, v28, v24, s40
    v_perm_b32 v69, v28, v24, s41
    v_perm_b32 v73, v29, v25, s40
    v_perm_b32 v77, v29, v25, s41
    v_perm_b32 v81, v30, v26, s40
    v_perm_b32 v85, v30, v26, s41
    v_perm_b32 v89, v31, v27, s40
    v_perm_b32 v93, v31, v27, s41
    s_waitcnt vmcnt(5)
    s_add_u32 s44, s44, s45
    s_cbranch_vccz VD10
    s_waitcnt vmcnt(3)
VD10:
    buffer_load_dwordx4 v[24:27], v8, s[24:27], s44 offen nt
    s_waitcnt vmcnt(5)
    s_add_u32 s44, s44, s45
    s_cbranch_vccz VD11
    s_waitcnt vmcnt(3)
VD11:
    buffer_load_dwordx4 v[28:31], v8, s[24:27], s44 offen nt
    v_perm_b32 v66, v36, v32, s40
    v_perm_b32 v70, v36, v32, s41
    v_perm_b32 v74, v37, v33, s40
    v_perm_b32 v78, v37, v33, s41
    v_perm_b32 v82, v38, v34, s40
    v_perm_b32 v86, v38, v34, s41
    v_perm_b32 v90, v39, v35, s40
    v_perm_b32 v94, v39, v35, s41
    s_waitcnt vmcnt(5)
    s_add_u32 s44, s44, s45
    s_cbranch_vccz VD12
    s_waitcnt vmcnt(3)
VD12:
    buffer_load_dwordx4 v[32:35], v8, s[24:27], s44 offen nt
    s_waitcnt vmcnt(5)
    s_add_u32 s44, s44, s45
    s_cbranch_vccz VD13
    s_waitcnt vmcnt(3)
VD13:
    buffer_load_dwordx4 v[36:39], v8, s[24:27], s44 offen nt
    v_perm_b32 v67, v44, v40, s40
    v_perm_b32 v71, v44, v40, s41
    v_perm_b32 v75, v45, v41, s40
    v_perm_b32 v79, v45, v41, s41
    v_perm_b32 v83, v46, v42, s40
    v_perm_b32 v87, v46, v42, s41
    v_perm_b32 v91, v47, v43, s40
    v_perm_b32 v95, v47, v43, s41
    s_waitcnt vmcnt(5)
    s_add_u32 s44, s44, s45
    s_cbranch_vccz VD14
    s_waitcnt vmcnt(3)
VD14:
    buffer_load_dwordx4 v[40:43], v8, s[24:27], s44 offen nt
    s_waitcnt vmcnt(5)
    s_add_u32 s44, s44, s45
    s_cbranch_vccz VD15
    s_waitcnt vmcnt(3)
VD15:
    buffer_load_dwordx4 v[44:47], v8, s[24:27], s44 offen nt
    v_perm_b32 v96, v20, v16, s40
    v_perm_b32 v100, v20, v16, s41
    v_perm_b32 v104, v21, v17, s40
    v_perm_b32 v108, v21, v17, s41
    v_perm_b32 v112, v22, v18, s40
    v_perm_b32 v116, v22, v18, s41
    v_perm_b32 v120, v23, v19, s40
    v_perm_b32 v124, v23, v19, s41
    s_waitcnt vmcnt(5)
    s_add_u32 s44, s44, 230400
    s_cbranch_vccz VD16
    s_waitcnt vmcnt(3)
VD16:
    buffer_load_dwordx4 v[16:19], v8, s[24:27], s44 offen nt
    s_waitcnt vmcnt(5)
    s_add_u32 s44, s44, s45
    s_cbranch_vccz VD17
    s_waitcnt vmcnt(3)
VD17:
    buffer_load_dwordx4 v[20:23], v8, s[24:27], s44 offen nt
    v_perm_b32 v97, v28, v24, s40
    v_perm_b32 v101, v28, v24, s41
    v_perm_b32 v105, v29, v25, s40
    v_perm_b32 v109, v29, v25, s41
    v_perm_b32 v113, v30, v26, s40
    v_perm_b32 v117, v30, v26, s41
    v_perm_b32 v121, v31, v27, s40
    v_perm_b32 v125, v31, v27, s41
    s_waitcnt vmcnt(5)
    s_add_u32 s44, s44, s45
    s_cbranch_vccz VD18
    s_waitcnt vmcnt(3)
VD18:
    buffer_load_dwordx4 v[24:27], v8, s[24:27], s44 offen nt
    s_waitcnt vmcnt(5)
    s_add_u32 s44, s44, s45
    s_cbranch_vccz VD19
    s_waitcnt vmcnt(3)
VD19:
    buffer_load_dwordx4 v[28:31], v8, s[24:27], s44 offen nt
    v_perm_b32 v98, v36, v32, s40
    v_perm_b32 v102, v36, v32, s41
    v_perm_b32 v106, v37, v33, s40
    v_perm_b32 v110, v37, v33, s41
    v_perm_b32 v114, v38, v34, s40
    v_perm_b32 v118, v38, v34, s41
    v_perm_b32 v122, v39, v35, s40
    v_perm_b32 v126, v39, v35, s41
    s_waitcnt vmcnt(5)
    s_add_u32 s44, s44, s45
    s_cbranch_vccz VD20
    s_waitcnt vmcnt(3)
VD20:
    buffer_load_dwordx4 v[32:35], v8, s[24:27], s44 offen nt
    s_waitcnt vmcnt(5)
    s_add_u32 s44, s44, s45
    s_cbranch_vccz VD21
    s_waitcnt vmcnt(3)
VD21:
    buffer_load_dwordx4 v[36:39], v8, s[24:27], s44 offen nt
    v_perm_b32 v99, v44, v40, s40
    v_perm_b32 v103, v44, v40, s41
    v_perm_b32 v107, v45, v41, s40
    v_perm_b32 v111, v45, v41, s41
    v_perm_b32 v115, v46, v42, s40
    v_perm_b32 v119, v46, v42, s41
    v_perm_b32 v123, v47, v43, s40
    v_perm_b32 v127, v47, v43, s41
    s_waitcnt vmcnt(5)
    s_add_u32 s44, s44, s45
    s_cbranch_vccz VD22
    s_waitcnt vmcnt(3)
VD22:
    buffer_load_dwordx4 v[40:43], v8, s[24:27], s44 offen nt
    s_waitcnt vmcnt(5)
    s_add_u32 s44, s44, s45
    s_cbranch_vccz VD23
    s_waitcnt vmcnt(3)
VD23:
    buffer_load_dwordx4 v[44:47], v8, s[24:27], s44 offen nt
    v_perm_b32 v128, v20, v16, s40
    v_perm_b32 v132, v20, v16, s41
    v_perm_b32 v136, v21, v17, s40
    v_perm_b32 v140, v21, v17, s41
    v_perm_b32 v144, v22, v18, s40
    v_perm_b32 v148, v22, v18, s41
    v_perm_b32 v152, v23, v19, s40
    v_perm_b32 v156, v23, v19, s41
    s_waitcnt vmcnt(5)
    s_add_u32 s44, s44, 230400
    s_cbranch_vccz VD24
    s_waitcnt vmcnt(3)
VD24:
    buffer_load_dwordx4 v[16:19], v8, s[24:27], s44 offen nt
    s_waitcnt vmcnt(5)
    s_add_u32 s44, s44, s45
    s_cbranch_vccz VD25
    s_waitcnt vmcnt(3)
VD25:
    buffer_load_dwordx4 v[20:23], v8, s[24:27], s44 offen nt
    v_perm_b32 v129, v28, v24, s40
    v_perm_b32 v133, v28, v24, s41
    v_perm_b32 v137, v29, v25, s40
    v_perm_b32 v141, v29, v25, s41
    v_perm_b32 v145, v30, v26, s40
    v_perm_b32 v149, v30, v26, s41
    v_perm_b32 v153, v31, v27, s40
    v_perm_b32 v157, v31, v27, s41
    s_waitcnt vmcnt(5)
    buffer_load_dwordx2 v[10:11], v12, s[36:39], 0 offen sc1
    buffer_load_dwordx4 v[56:59], v9, s[28:31], s47 offen sc1
    buffer_load_dwordx4 v[60:63], v9, s[28:31], s47 offen offset:16 sc1
    s_add_u32 s44, s44, s45
    s_cbranch_vccz VD26
    s_waitcnt vmcnt(6)
VD26:
    buffer_load_dwordx4 v[24:27], v8, s[24:27], s44 offen nt
    s_waitcnt vmcnt(8)
    s_add_u32 s44, s44, s45
    s_cbranch_vccz VD27
    s_waitcnt vmcnt(6)
VD27:
    buffer_load_dwordx4 v[28:31], v8, s[24:27], s44 offen nt
    v_perm_b32 v130, v36, v32, s40
    v_perm_b32 v134, v36, v32, s41
    v_perm_b32 v138, v37, v33, s40
    v_perm_b32 v142, v37, v33, s41
    v_perm_b32 v146, v38, v34, s40
    v_perm_b32 v150, v38, v34, s41
    v_perm_b32 v154, v39, v35, s40
    v_perm_b32 v158, v39, v35, s41
    s_waitcnt vmcnt(8)
    s_add_u32 s44, s44, s45
    s_cbranch_vccz VD28
    s_waitcnt vmcnt(6)
VD28:
    buffer_load_dwordx4 v[32:35], v8, s[24:27], s44 offen nt
    s_waitcnt vmcnt(8)
    s_add_u32 s44, s44, s45
    s_cbranch_vccz VD29
    s_waitcnt vmcnt(6)
VD29:
    buffer_load_dwordx4 v[36:39], v8, s[24:27], s44 offen nt
    v_perm_b32 v131, v44, v40, s40
    v_perm_b32 v135, v44, v40, s41
    v_perm_b32 v139, v45, v41, s40
    v_perm_b32 v143, v45, v41, s41
    v_perm_b32 v147, v46, v42, s40
    v_perm_b32 v151, v46, v42, s41
    v_perm_b32 v155, v47, v43, s40
    v_perm_b32 v159, v47, v43, s41
    s_waitcnt vmcnt(8)
    s_add_u32 s44, s44, s45
    s_cbranch_vccz VD30
    s_waitcnt vmcnt(3)
VD30:
    buffer_load_dwordx4 v[40:43], v8, s[24:27], s44 offen nt
    s_waitcnt vmcnt(8)
    s_add_u32 s44, s44, s45
    s_cbranch_vccz VD31
    s_waitcnt vmcnt(3)
VD31:
    buffer_load_dwordx4 v[44:47], v8, s[24:27], s44 offen nt
    v_perm_b32 v160, v20, v16, s40
    v_perm_b32 v164, v20, v16, s41
    v_perm_b32 v168, v21, v17, s40
    v_perm_b32 v172, v21, v17, s41
    v_perm_b32 v176, v22, v18, s40
    v_perm_b32 v180, v22, v18, s41
    v_perm_b32 v184, v23, v19, s40
    v_perm_b32 v188, v23, v19, s41
    s_waitcnt vmcnt(6)
    v_cmp_ne_u32 s[48:49], v57, v10
    v_cmp_ne_u32 s[50:51], v59, v10
    v_cmp_ne_u32 s[52:53], v61, v10
    v_cmp_ne_u32 s[54:55], v63, v10
    s_or_b64 s[48:49], s[48:49], s[50:51]
    s_or_b64 s[52:53], s[52:53], s[54:55]
    v_cmp_ne_u32 vcc, 1, v11
    s_or_b64 s[48:49], s[48:49], vcc
    s_or_b64 s[56:57], s[48:49], s[52:53]
    s_cbranch_scc1 V_RETRY
V_GOT:
    s_load_dwordx8 s[48:55], s[20:21], s68
    v_readfirstlane_b32 s60, v10
    v_mov_b32_dpp v192, v56 quad_perm:[0,1,2,3] row_mask:0xf bank_mask:0x1
    v_mov_b32_dpp v193, v58 quad_perm:[0,1,2,3] row_mask:0xf bank_mask:0x1
    v_mov_b32_dpp v194, v60 quad_perm:[0,1,2,3] row_mask:0xf bank_mask:0x1
    v_mov_b32_dpp v195, v62 quad_perm:[0,1,2,3] row_mask:0xf bank_mask:0x1
    v_mov_b32_dpp v196, v56 row_shr:4 row_mask:0xf bank_mask:0x2
    v_mov_b32_dpp v197, v58 row_shr:4 row_mask:0xf bank_mask:0x2
    v_mov_b32_dpp v198, v60 row_shr:4 row_mask:0xf bank_mask:0x2
    v_mov_b32_dpp v199, v62 row_shr:4 row_mask:0xf bank_mask:0x2
    v_mov_b32_dpp v200, v56 row_shr:8 row_mask:0xf bank_mask:0x4
    v_mov_b32_dpp v201, v58 row_shr:8 row_mask:0xf bank_mask:0x4
    v_mov_b32_dpp v202, v60 row_shr:8 row_mask:0xf bank_mask:0x4
    v_mov_b32_dpp v203, v62 row_shr:8 row_mask:0xf bank_mask:0x4
    v_mov_b32_dpp v204, v56 row_shr:12 row_mask:0xf bank_mask:0x8
    v_mov_b32_dpp v205, v58 row_shr:12 row_mask:0xf bank_mask:0x8
    v_mov_b32_dpp v206, v60 row_shr:12 row_mask:0xf bank_mask:0x8
    v_mov_b32_dpp v207, v62 row_shr:12 row_mask:0xf bank_mask:0x8
    s_nop 1
    v_mfma_f32_16x16x32_bf16 v[224:227], v[192:195], v[64:67], 0
    v_mfma_f32_16x16x32_bf16 v[228:231], v[192:195], v[80:83], 0
    v_mfma_f32_16x16x32_bf16 v[224:227], v[196:199], v[68:71], v[224:227]
    v_mfma_f32_16x16x32_bf16 v[228:231], v[196:199], v[84:87], v[228:231]
    v_mfma_f32_16x16x32_bf16 v[224:227], v[200:203], v[72:75], v[224:227]
    v_mfma_f32_16x16x32_bf16 v[228:231], v[200:203], v[88:91], v[228:231]
    v_mfma_f32_16x16x32_bf16 v[224:227], v[204:207], v[76:79], v[224:227]
    v_mfma_f32_16x16x32_bf16 v[228:231], v[204:207], v[92:95], v[228:231]
    v_mov_b32_dpp v192, v56 row_shl:4 row_mask:0xf bank_mask:0x1
    v_mov_b32_dpp v193, v58 row_shl:4 row_mask:0xf bank_mask:0x1
    v_mov_b32_dpp v194, v60 row_shl:4 row_mask:0xf bank_mask:0x1
    v_mov_b32_dpp v195, v62 row_shl:4 row_mask:0xf bank_mask:0x1
    v_mov_b32_dpp v196, v56 quad_perm:[0,1,2,3] row_mask:0xf bank_mask:0x2
    v_mov_b32_dpp v197, v58 quad_perm:[0,1,2,3] row_mask:0xf bank_mask:0x2
    v_mov_b32_dpp v198, v60 quad_perm:[0,1,2,3] row_mask:0xf bank_mask:0x2
    v_mov_b32_dpp v199, v62 quad_perm:[0,1,2,3] row_mask:0xf bank_mask:0x2
    v_mov_b32_dpp v200, v56 row_shr:4 row_mask:0xf bank_mask:0x4
    v_mov_b32_dpp v201, v58 row_shr:4 row_mask:0xf bank_mask:0x4
    v_mov_b32_dpp v202, v60 row_shr:4 row_mask:0xf bank_mask:0x4
    v_mov_b32_dpp v203, v62 row_shr:4 row_mask:0xf bank_mask:0x4
    v_mov_b32_dpp v204, v56 row_shr:8 row_mask:0xf bank_mask:0x8
    v_mov_b32_dpp v205, v58 row_shr:8 row_mask:0xf bank_mask:0x8
    v_mov_b32_dpp v206, v60 row_shr:8 row_mask:0xf bank_mask:0x8
    v_mov_b32_dpp v207, v62 row_shr:8 row_mask:0xf bank_mask:0x8
    s_nop 1
    v_mfma_f32_16x16x32_bf16 v[224:227], v[192:195], v[96:99], v[224:227]
    v_mfma_f32_16x16x32_bf16 v[228:231], v[192:195], v[112:115], v[228:231]
    v_mfma_f32_16x16x32_bf16 v[224:227], v[196:199], v[100:103], v[224:227]
    v_mfma_f32_16x16x32_bf16 v[228:231], v[196:199], v[116:119], v[228:231]
    v_mfma_f32_16x16x32_bf16 v[224:227], v[200:203], v[104:107], v[224:227]
    v_mfma_f32_16x16x32_bf16 v[228:231], v[200:203], v[120:123], v[228:231]
    v_mfma_f32_16x16x32_bf16 v[224:227], v[204:207], v[108:111], v[224:227]
    v_mfma_f32_16x16x32_bf16 v[228:231], v[204:207], v[124:127], v[228:231]
    v_mov_b32_dpp v192, v56 row_shl:8 row_mask:0xf bank_mask:0x1
    v_mov_b32_dpp v193, v58 row_shl:8 row_mask:0xf bank_mask:0x1
    v_mov_b32_dpp v194, v60 row_shl:8 row_mask:0xf bank_mask:0x1
    v_mov_b32_dpp v195, v62 row_shl:8 row_mask:0xf bank_mask:0x1
    v_mov_b32_dpp v196, v56 row_shl:4 row_mask:0xf bank_mask:0x2
    v_mov_b32_dpp v197, v58 row_shl:4 row_mask:0xf bank_mask:0x2
    v_mov_b32_dpp v198, v60 row_shl:4 row_mask:0xf bank_mask:0x2
    v_mov_b32_dpp v199, v62 row_shl:4 row_mask:0xf bank_mask:0x2
    v_mov_b32_dpp v200, v56 quad_perm:[0,1,2,3] row_mask:0xf bank_mask:0x4
    v_mov_b32_dpp v201, v58 quad_perm:[0,1,2,3] row_mask:0xf bank_mask:0x4
    v_mov_b32_dpp v202, v60 quad_perm:[0,1,2,3] row_mask:0xf bank_mask:0x4
    v_mov_b32_dpp v203, v62 quad_perm:[0,1,2,3] row_mask:0xf bank_mask:0x4
    v_mov_b32_dpp v204, v56 row_shr:4 row_mask:0xf bank_mask:0x8
    v_mov_b32_dpp v205, v58 row_shr:4 row_mask:0xf bank_mask:0x8
    v_mov_b32_dpp v206, v60 row_shr:4 row_mask:0xf bank_mask:0x8
    v_mov_b32_dpp v207, v62 row_shr:4 row_mask:0xf bank_mask:0x8
    s_nop 1
    v_mfma_f32_16x16x32_bf16 v[224:227], v[192:195], v[128:131], v[224:227]
    v_mfma_f32_16x16x32_bf16 v[228:231], v[192:195], v[144:147], v[228:231]
    v_mfma_f32_16x16x32_bf16 v[224:227], v[196:199], v[132:135], v[224:227]
    v_mfma_f32_16x16x32_bf16 v[228:231], v[196:199], v[148:151], v[228:231]
    v_mfma_f32_16x16x32_bf16 v[224:227], v[200:203], v[136:139], v[224:227]
    v_mfma_f32_16x16x32_bf16 v[228:231], v[200:203], v[152:155], v[228:231]
    v_mfma_f32_16x16x32_bf16 v[224:227], v[204:207], v[140:143], v[224:227]
    v_mfma_f32_16x16x32_bf16 v[228:231], v[204:207], v[156:159], v[228:231]
    v_mov_b32_dpp v208, v56 row_shl:12 row_mask:0xf bank_mask:0x1
    v_mov_b32_dpp v209, v58 row_shl:12 row_mask:0xf bank_mask:0x1
    v_mov_b32_dpp v210, v60 row_shl:12 row_mask:0xf bank_mask:0x1
    v_mov_b32_dpp v211, v62 row_shl:12 row_mask:0xf bank_mask:0x1
    v_mov_b32_dpp v212, v56 row_shl:8 row_mask:0xf bank_mask:0x2
    v_mov_b32_dpp v213, v58 row_shl:8 row_mask:0xf bank_mask:0x2
    v_mov_b32_dpp v214, v60 row_shl:8 row_mask:0xf bank_mask:0x2
    v_mov_b32_dpp v215, v62 row_shl:8 row_mask:0xf bank_mask:0x2
    v_mov_b32_dpp v216, v56 row_shl:4 row_mask:0xf bank_mask:0x4
    v_mov_b32_dpp v217, v58 row_shl:4 row_mask:0xf bank_mask:0x4
    v_mov_b32_dpp v218, v60 row_shl:4 row_mask:0xf bank_mask:0x4
    v_mov_b32_dpp v219, v62 row_shl:4 row_mask:0xf bank_mask:0x4
    v_mov_b32_dpp v220, v56 quad_perm:[0,1,2,3] row_mask:0xf bank_mask:0x8
    v_mov_b32_dpp v221, v58 quad_perm:[0,1,2,3] row_mask:0xf bank_mask:0x8
    v_mov_b32_dpp v222, v60 quad_perm:[0,1,2,3] row_mask:0xf bank_mask:0x8
    v_mov_b32_dpp v223, v62 quad_perm:[0,1,2,3] row_mask:0xf bank_mask:0x8
    v_mov_b32 v240, v10
    v_lshrrev_b32 v241, 8, v10
    v_lshrrev_b32 v242, 16, v10
    v_lshrrev_b32 v243, 24, v10
    s_xor_b32 s76, s76, s60
    s_mov_b32 s77, s76
    s_waitcnt lgkmcnt(0)
    s_xor_b64 s[48:49], s[48:49], s[76:77]
    s_xor_b64 s[50:51], s[50:51], s[76:77]
    s_xor_b64 s[52:53], s[52:53], s[76:77]
    s_xor_b64 s[54:55], s[54:55], s[76:77]
    s_or_b64 s[48:49], s[48:49], s[50:51]
    s_or_b64 s[52:53], s[52:53], s[54:55]
    s_or_b64 s[64:65], s[48:49], s[52:53]
    s_waitcnt vmcnt(4)
    v_perm_b32 v161, v28, v24, s40
    v_perm_b32 v165, v28, v24, s41
    v_perm_b32 v169, v29, v25, s40
    v_perm_b32 v173, v29, v25, s41
    v_perm_b32 v177, v30, v26, s40
    v_perm_b32 v181, v30, v26, s41
    v_perm_b32 v185, v31, v27, s40
    v_perm_b32 v189, v31, v27, s41
    s_waitcnt vmcnt(2)
    v_perm_b32 v162, v36, v32, s40
    v_perm_b32 v166, v36, v32, s41
    v_perm_b32 v170, v37, v33, s40
    v_perm_b32 v174, v37, v33, s41
    v_perm_b32 v178, v38, v34, s40
    v_perm_b32 v182, v38, v34, s41
    v_perm_b32 v186, v39, v35, s40
    v_perm_b32 v190, v39, v35, s41
    s_waitcnt vmcnt(0)
    v_perm_b32 v163, v44, v40, s40
    v_perm_b32 v167, v44, v40, s41
    v_perm_b32 v171, v45, v41, s40
    v_perm_b32 v175, v45, v41, s41
    v_perm_b32 v179, v46, v42, s40
    v_perm_b32 v183, v46, v42, s41
    v_perm_b32 v187, v47, v43, s40
    v_perm_b32 v191, v47, v43, s41
    s_nop 1
    v_mfma_f32_16x16x32_bf16 v[224:227], v[208:211], v[160:163], v[224:227]
    v_mfma_f32_16x16x32_bf16 v[228:231], v[208:211], v[176:179], v[228:231]
    v_mfma_f32_16x16x32_bf16 v[224:227], v[212:215], v[164:167], v[224:227]
    v_mfma_f32_16x16x32_bf16 v[228:231], v[212:215], v[180:183], v[228:231]
    v_mfma_f32_16x16x32_bf16 v[224:227], v[216:219], v[168:171], v[224:227]
    v_mfma_f32_16x16x32_bf16 v[228:231], v[216:219], v[184:187], v[228:231]
    v_mfma_f32_16x16x32_bf16 v[224:227], v[220:223], v[172:175], v[224:227]
    v_mfma_f32_16x16x32_bf16 v[228:231], v[220:223], v[188:191], v[228:231]
    s_cmp_eq_u32 s74, s75
    s_cbranch_scc1 V_DES
    s_lshl_b32 s74, s74, 2
    v_add_u32 v15, s74, v15
    s_nop 3
    ds_write_b128 v14, v[224:227] offset:46080
    ds_write_b128 v14, v[228:231] offset:47104
    ds_write_b32 v15, v7 offset:36864
V_FIN:
    s_endpgm
V_DES:
    s_cmp_eq_u32 s74, 0
    s_cbranch_scc1 V_PUB0
V_DRETRY:
    ds_read_b128 v[16:19], v15 offset:36864
    ds_read_b128 v[64:67], v14 offset:44032
    ds_read_b128 v[68:71], v14 offset:45056
    s_cmp_eq_u32 s74, 1
    s_cbranch_scc1 V_DWAIT
    ds_read_b128 v[72:75], v14 offset:41984
    ds_read_b128 v[76:79], v14 offset:43008
    s_cmp_eq_u32 s74, 2
    s_cbranch_scc1 V_DWAIT
    ds_read_b128 v[80:83], v14 offset:39936
    ds_read_b128 v[84:87], v14 offset:40960
    s_cmp_eq_u32 s74, 3
    s_cbranch_scc1 V_DWAIT
    ds_read_b128 v[88:91], v14 offset:37888
    ds_read_b128 v[92:95], v14 offset:38912
V_DWAIT:
    s_waitcnt lgkmcnt(0)
    v_add3_u32 v16, v16, v17, v18
    v_add_u32 v16, v16, v19
    v_cmp_ne_u32 vcc, s74, v16
    s_cbranch_vccz V_DOK
    s_sub_u32 s46, s46, 1
    s_cmp_lg_u32 s46, 0
    s_cbranch_scc1 V_DRETRY
V_DOK:
    v_pk_add_f32 v[224:225], v[224:225], v[64:65]
    v_pk_add_f32 v[226:227], v[226:227], v[66:67]
    v_pk_add_f32 v[228:229], v[228:229], v[68:69]
    v_pk_add_f32 v[230:231], v[230:231], v[70:71]
    s_cmp_eq_u32 s74, 1
    s_cbranch_scc1 V_PUB
    v_pk_add_f32 v[224:225], v[224:225], v[72:73]
    v_pk_add_f32 v[226:227], v[226:227], v[74:75]
    v_pk_add_f32 v[228:229], v[228:229], v[76:77]
    v_pk_add_f32 v[230:231], v[230:231], v[78:79]
    s_cmp_eq_u32 s74, 2
    s_cbranch_scc1 V_PUB
    v_pk_add_f32 v[224:225], v[224:225], v[80:81]
    v_pk_add_f32 v[226:227], v[226:227], v[82:83]
    v_pk_add_f32 v[228:229], v[228:229], v[84:85]
    v_pk_add_f32 v[230:231], v[230:231], v[86:87]
    s_cmp_eq_u32 s74, 3
    s_cbranch_scc1 V_PUB
    v_pk_add_f32 v[224:225], v[224:225], v[88:89]
    v_pk_add_f32 v[226:227], v[226:227], v[90:91]
    v_pk_add_f32 v[228:229], v[228:229], v[92:93]
    v_pk_add_f32 v[230:231], v[230:231], v[94:95]
    s_branch V_PUB
V_PUB0:
    s_nop 4
V_PUB:
    ds_write_b32 v12, v7 offset:36912
    v_bfi_b32 v232, s71, v240, v224
    v_bfi_b32 v233, s71, v241, v225
    v_bfi_b32 v234, s71, v242, v226
    v_bfi_b32 v235, s71, v243, v227
    s_cmp_lg_u64 s[64:65], 0
    s_cbranch_scc1 V_PUBX
    buffer_store_dwordx4 v[232:235], v13, s[28:31], s69 offen
    v_bfi_b32 v236, s71, v240, v228
    v_bfi_b32 v237, s71, v241, v229
    v_bfi_b32 v238, s71, v242, v230
    v_bfi_b32 v239, s71, v243, v231
    buffer_store_dwordx4 v[236:239], v13, s[28:31], s69 offen offset:256
    s_endpgm
V_PUBX:
    buffer_store_dwordx4 v[232:235], v13, s[28:31], s69 offen sc1
    v_bfi_b32 v236, s71, v240, v228
    v_bfi_b32 v237, s71, v241, v229
    v_bfi_b32 v238, s71, v242, v230
    v_bfi_b32 v239, s71, v243, v231
    buffer_store_dwordx4 v[236:239], v13, s[28:31], s69 offen offset:256 sc1
    s_endpgm
V_RETRY:
    s_sleep 10
    buffer_load_dwordx2 v[10:11], v12, s[36:39], 0 offen sc1
    buffer_load_dwordx4 v[56:59], v9, s[28:31], s47 offen sc1
    buffer_load_dwordx4 v[60:63], v9, s[28:31], s47 offen offset:16 sc1
    s_waitcnt vmcnt(0)
    v_cmp_ne_u32 s[48:49], v57, v10
    v_cmp_ne_u32 s[50:51], v59, v10
    v_cmp_ne_u32 s[52:53], v61, v10
    v_cmp_ne_u32 s[54:55], v63, v10
    s_or_b64 s[48:49], s[48:49], s[50:51]
    s_or_b64 s[52:53], s[52:53], s[54:55]
    v_cmp_ne_u32 vcc, 1, v11
    s_or_b64 s[48:49], s[48:49], vcc
    s_or_b64 s[56:57], s[48:49], s[52:53]
    s_cbranch_scc0 V_GOT
    s_sub_u32 s46, s46, 1
    s_cmp_lg_u32 s46, 0
    s_cbranch_scc1 V_RETRY
    s_branch V_GOT
A_V:
    s_load_dwordx4 s[64:67], s[68:69], s77
    s_sub_u32 s72, s59, 4
    s_mov_b64 vcc, 0
    s_barrier
    s_branch V_ENTRY
X_W7:
    s_load_dwordx4 s[64:67], s[68:69], s77
    s_mov_b32 s72, 5
    s_mov_b64 vcc, 0
    s_barrier
    s_barrier
    s_branch V_ENTRY
X_MAIN:
    s_load_dword s62, s[20:21], 0
    s_load_dwordx4 s[64:67], s[68:69], s77
    s_mov_b64 s[28:29], s[20:21]
    s_mov_b32 s30, 1605632
    s_mov_b32 s31, 0x00020000
    s_mov_b32 s40, 0x05040100
    s_mov_b32 s41, 0x07060302
    s_mul_i32 s45, s60, 3
    v_add_u32 v11, s45, v5
    v_lshlrev_b32 v11, 11, v11
    v_lshl_add_u32 v11, v7, 4, v11
    v_cmp_eq_u32 s[50:51], v3, v5
    v_cmp_gt_u32 vcc, 3, v5
    s_and_b64 s[50:51], s[50:51], vcc
    v_mul_u32_u24 v112, 576, v7
    v_lshl_add_u32 v112, v5, 4, v112
    v_lshl_add_u32 v112, v3, 2, v112
    v_mul_u32_u24 v113, 2304, v3
    v_lshl_add_u32 v113, v4, 3, v113
    s_lshl_b32 s58, s3, 7
    s_add_u32 s58, s58, 4096
    s_sub_u32 s72, s60, 1
    s_waitcnt vmcnt(7)
    v_perm_b32 v48, v20, v16, s40
    v_perm_b32 v52, v20, v16, s41
    v_perm_b32 v56, v21, v17, s40
    v_perm_b32 v60, v21, v17, s41
    v_perm_b32 v64, v22, v18, s40
    v_perm_b32 v68, v22, v18, s41
    v_perm_b32 v72, v23, v19, s40
    v_perm_b32 v76, v23, v19, s41
    s_waitcnt vmcnt(5)
    v_perm_b32 v49, v28, v24, s40
    v_perm_b32 v53, v28, v24, s41
    v_perm_b32 v57, v29, v25, s40
    v_perm_b32 v61, v29, v25, s41
    v_perm_b32 v65, v30, v26, s40
    v_perm_b32 v69, v30, v26, s41
    v_perm_b32 v73, v31, v27, s40
    v_perm_b32 v77, v31, v27, s41
    s_waitcnt vmcnt(3)
    v_perm_b32 v50, v36, v32, s40
    v_perm_b32 v54, v36, v32, s41
    v_perm_b32 v58, v37, v33, s40
    v_perm_b32 v62, v37, v33, s41
    v_perm_b32 v66, v38, v34, s40
    v_perm_b32 v70, v38, v34, s41
    v_perm_b32 v74, v39, v35, s40
    v_perm_b32 v78, v39, v35, s41
    s_waitcnt vmcnt(1)
    v_perm_b32 v51, v44, v40, s40
    v_perm_b32 v55, v44, v40, s41
    v_perm_b32 v59, v45, v41, s40
    v_perm_b32 v63, v45, v41, s41
    v_perm_b32 v67, v46, v42, s40
    v_perm_b32 v71, v46, v42, s41
    v_perm_b32 v75, v47, v43, s40
    v_perm_b32 v79, v47, v43, s41
    s_waitcnt vmcnt(0)
    s_nop 1
    v_mfma_f32_16x16x32_bf16 v[80:83], v[12:15], v[48:51], 0
    v_mfma_f32_16x16x32_bf16 v[84:87], v[12:15], v[52:55], 0
    v_mfma_f32_16x16x32_bf16 v[88:91], v[12:15], v[56:59], 0
    v_mfma_f32_16x16x32_bf16 v[92:95], v[12:15], v[60:63], 0
    v_mfma_f32_16x16x32_bf16 v[96:99], v[12:15], v[64:67], 0
    v_mfma_f32_16x16x32_bf16 v[100:103], v[12:15], v[68:71], 0
    v_mfma_f32_16x16x32_bf16 v[104:107], v[12:15], v[72:75], 0
    v_mfma_f32_16x16x32_bf16 v[108:111], v[12:15], v[76:79], 0
    s_mov_b64 exec, s[50:51]
    s_nop 0
    ds_write_b128 v11, v[80:83] offset:0
    ds_write_b128 v11, v[84:87] offset:256
    ds_write_b128 v11, v[88:91] offset:576
    ds_write_b128 v11, v[92:95] offset:832
    ds_write_b128 v11, v[96:99] offset:1152
    ds_write_b128 v11, v[100:103] offset:1408
    ds_write_b128 v11, v[104:107] offset:1728
    ds_write_b128 v11, v[108:111] offset:1984
    s_mov_b64 exec, -1
    s_mov_b64 vcc, 0
    s_waitcnt lgkmcnt(0)
    s_barrier
    s_cmp_eq_u32 s60, 0
    s_cbranch_scc1 X_RED
    s_barrier
    s_branch V_ENTRY
X_RED:
    ds_read2st64_b32 v[16:17], v112 offset0:0 offset1:1
    ds_read2st64_b32 v[18:19], v112 offset0:8 offset1:9
    ds_read2st64_b32 v[20:21], v112 offset0:16 offset1:17
    ds_read2st64_b32 v[22:23], v112 offset0:24 offset1:25
    ds_read2st64_b32 v[24:25], v112 offset0:32 offset1:33
    ds_read2st64_b32 v[26:27], v112 offset0:40 offset1:41
    ds_read2st64_b32 v[28:29], v112 offset0:48 offset1:49
    ds_read2st64_b32 v[30:31], v112 offset0:56 offset1:57
    ds_read2st64_b32 v[32:33], v112 offset0:64 offset1:65
    ds_read2st64_b32 v[34:35], v112 offset0:72 offset1:73
    ds_read2st64_b32 v[36:37], v112 offset0:80 offset1:81
    ds_read2st64_b32 v[38:39], v112 offset0:88 offset1:89
    s_waitcnt lgkmcnt(6)
    ds_read2st64_b32 v[40:41], v112 offset0:96 offset1:97
    ds_read2st64_b32 v[42:43], v112 offset0:104 offset1:105
    ds_read2st64_b32 v[44:45], v112 offset0:112 offset1:113
    ds_read2st64_b32 v[46:47], v112 offset0:120 offset1:121
    ds_read2st64_b32 v[48:49], v112 offset0:128 offset1:129
    ds_read2st64_b32 v[50:51], v112 offset0:136 offset1:137
    s_and_b32 s61, s62, 0x7f7f7f7f
    s_add_u32 s61, s61, 0x01010101
    s_and_b32 s62, s62, 0x80808080
    s_xor_b32 s62, s62, s61
    s_waitcnt lgkmcnt(12)
    v_pk_add_f32 v[16:17], v[16:17], v[18:19]
    s_waitcnt lgkmcnt(12)
    v_pk_add_f32 v[20:21], v[20:21], v[22:23]
    v_pk_add_f32 v[16:17], v[16:17], v[20:21]
    s_waitcnt lgkmcnt(12)
    v_pk_add_f32 v[24:25], v[24:25], v[26:27]
    v_pk_add_f32 v[16:17], v[16:17], v[24:25]
    s_waitcnt lgkmcnt(10)
    v_pk_add_f32 v[28:29], v[28:29], v[30:31]
    v_pk_add_f32 v[16:17], v[16:17], v[28:29]
    s_waitcnt lgkmcnt(8)
    v_pk_add_f32 v[32:33], v[32:33], v[34:35]
    v_pk_add_f32 v[16:17], v[16:17], v[32:33]
    s_waitcnt lgkmcnt(6)
    v_pk_add_f32 v[36:37], v[36:37], v[38:39]
    v_pk_add_f32 v[16:17], v[16:17], v[36:37]
    s_waitcnt lgkmcnt(4)
    v_pk_add_f32 v[40:41], v[40:41], v[42:43]
    v_pk_add_f32 v[16:17], v[16:17], v[40:41]
    s_waitcnt lgkmcnt(2)
    v_pk_add_f32 v[44:45], v[44:45], v[46:47]
    v_pk_add_f32 v[16:17], v[16:17], v[44:45]
    s_waitcnt lgkmcnt(0)
    v_pk_add_f32 v[48:49], v[48:49], v[50:51]
    v_pk_add_f32 v[16:17], v[16:17], v[48:49]
    v_cvt_pk_bf16_f32 v16, v16, v17
    v_mov_b32 v17, s62
    buffer_store_dwordx2 v[16:17], v113, s[28:31], s58 offen sc1
    s_barrier
    s_endpgm
RELAY:
    s_load_dword s62, s[20:21], 0
    v_mov_b32 v19, 1
    s_waitcnt lgkmcnt(0)
    s_and_b32 s61, s62, 0x7f7f7f7f
    s_add_u32 s61, s61, 0x01010101
    s_and_b32 s62, s62, 0x80808080
    s_xor_b32 s62, s62, s61
    v_mov_b32 v18, s62
    s_mov_b64 exec, 1
    buffer_store_dwordx2 v[18:19], v11, s[36:39], 0 offen sc1
    s_mov_b64 exec, -1
    s_branch G_TAG_OK
END:
    s_endpgm
CODE_END:
.p2align 6
.type TABLE,@object
TABLE:
.long 0x102, 0x3, 0x402a400, 0x20000
.long 0x502, 0x403, 0x14052400, 0x10048000
.long 0x902, 0x900802, 0x2407a400, 0x20071008
.long 0xd02, 0x900c02, 0x340a2400, 0x30099008
.long 0x482102, 0x1f8100a, 0x8416aac4, 0x400c3c5c
.long 0x1502, 0x1681402, 0x540f2340, 0x500eaa54
.long 0x1902, 0x1681812, 0x6411a340, 0x60112a54
.long 0x1d02, 0x1681c1a, 0x74142340, 0x7013aa54
.long 0x240102, 0x360003, 0x402ac02, 0x20803
.long 0x240502, 0x360403, 0x14052c02, 0x10048803
.long 0x240902, 0xb40802, 0x2407ac02, 0x2007180a
.long 0x240d02, 0xb40c02, 0x340a2c02, 0x3009980a
.long 0x6c2102, 0x21c100a, 0x8416b2c6, 0x400c445e
.long 0x241502, 0x18c1402, 0x540f2b42, 0x500eb256
.long 0x241902, 0x18c1812, 0x6411ab42, 0x60113256
.long 0x241d02, 0x18c1c1a, 0x74142b42, 0x7013b256
.long 0x480102, 0x6c0003, 0x402b404, 0x21006
.long 0x480502, 0x6c0403, 0x14053404, 0x10049006
.long 0x480902, 0xd80802, 0x2407b404, 0x2007200c
.long 0x480d02, 0xd80c02, 0x340a3404, 0x3009a00c
.long 0x902102, 0x240100a, 0x8416bac8, 0x400c4c60
.long 0x481502, 0x1b01402, 0x540f3344, 0x500eba58
.long 0x481902, 0x1b01812, 0x6411b344, 0x60113a58
.long 0x481d02, 0x1b01c1a, 0x74143344, 0x7013ba58
.long 0x6c0102, 0xa20003, 0x402bc06, 0x21809
.long 0x6c0502, 0xa20403, 0x14053c06, 0x10049809
.long 0x6c0902, 0xfc0802, 0x2407bc06, 0x2007280e
.long 0x6c0d02, 0xfc0c02, 0x340a3c06, 0x3009a80e
.long 0xb42102, 0x264100a, 0x8416c2ca, 0x400c5462
.long 0x6c1502, 0x1d41402, 0x540f3b46, 0x500ec25a
.long 0x6c1902, 0x1d41812, 0x6411bb46, 0x6011425a
.long 0x6c1d02, 0x1d41c1a, 0x74143b46, 0x7013c25a
.long 0x900102, 0xd80003, 0x402c408, 0x2200c
.long 0x900502, 0xd80403, 0x14054408, 0x1004a00c
.long 0x900902, 0x1200802, 0x2407c408, 0x20073010
.long 0x900d02, 0x1200c02, 0x340a4408, 0x3009b010
.long 0xd82102, 0x120a, 0x8416cacc, 0x480d4440
.long 0x901502, 0x1f81402, 0x540f4348, 0x500eca5c
.long 0x901902, 0x1f81812, 0x6411c348, 0x60114a5c
.long 0x901d02, 0x1f81c1a, 0x74144348, 0x7013ca5c
.long 0x6c0203, 0x303, 0x8035c06, 0xc03e000
.long 0x6c0603, 0x703, 0x1805dc06, 0x1c066000
.long 0xb40902, 0x1440802, 0x2407cc0a, 0x20073812
.long 0xb40d02, 0x1440c02, 0x340a4c0a, 0x3009b812
.long 0xfc2102, 0x24120a, 0x8416d2ce, 0x480d4c42
.long 0xb41502, 0x21c1402, 0x540f4b4a, 0x500ed25e
.long 0xb41902, 0x21c1812, 0x6411cb4a, 0x6011525e
.long 0xb41d02, 0x21c1c1a, 0x74144b4a, 0x7013d25e
.long 0xa20203, 0x360303, 0x8036409, 0xc03e803
.long 0xa20603, 0x360703, 0x1805e409, 0x1c066803
.long 0xd80902, 0x1680802, 0x2407d40c, 0x20074014
.long 0xd80d02, 0x1680c02, 0x340a540c, 0x3009c014
.long 0x1202102, 0x48120a, 0x8416dad0, 0x480d5444
.long 0xd81502, 0x2401402, 0x540f534c, 0x500eda60
.long 0xd81902, 0x2401812, 0x6411d34c, 0x60115a60
.long 0xd81d02, 0x2401c1a, 0x7414534c, 0x7013da60
.long 0xd80203, 0x6c0303, 0x8036c0c, 0xc03f006
.long 0xd80603, 0x6c0703, 0x1805ec0c, 0x1c067006
.long 0xfc0902, 0x18c0802, 0x2407dc0e, 0x20074816
.long 0xfc0d02, 0x18c0c02, 0x340a5c0e, 0x3009c816
.long 0x1442102, 0x6c120a, 0x8416e2d2, 0x480d5c46
.long 0xfc1502, 0x2641402, 0x540f5b4e, 0x500ee262
.long 0xfc1902, 0x2641812, 0x6411db4e, 0x60116262
.long 0xfc1d02, 0x2641c1a, 0x74145b4e, 0x7013e262
.long 0x10e0203, 0xa20303, 0x803748f, 0xc03f809
.long 0x10e0603, 0xa20703, 0x1805f48f, 0x1c067809
.long 0x1200902, 0x1b00802, 0x2407e490, 0x20075018
.long 0x1200d02, 0x1b00c02, 0x340a6490, 0x3009d018
.long 0x1682102, 0x90120a, 0x8416ea54, 0x480d6448
.long 0x1201502, 0x1602, 0x540f6490, 0x580fc240
.long 0x1201902, 0x1a12, 0x6411e490, 0x68124240
.long 0x1201d02, 0x1e1a, 0x74146490, 0x7814c240
.long 0xb40102, 0x10e0002, 0x402cc8a, 0x2280f
.long 0xb40502, 0x10e0402, 0x14054c8a, 0x1004a80f
.long 0x1440902, 0x1d40802, 0x2407ec92, 0x2007581a
.long 0x1440d02, 0x1d40c02, 0x340a6c92, 0x3009d81a
.long 0x1104, 0xb4120a, 0x440ca240, 0x480d6c4a
.long 0x1441502, 0x241602, 0x540f6c92, 0x580fca42
.long 0x1441902, 0x241a12, 0x6411ec92, 0x68124a42
.long 0x1441d02, 0x241e1a, 0x74146c92, 0x7814ca42
.long 0xd80102, 0x1320002, 0x402d48c, 0x23011
.long 0xd80502, 0x1320402, 0x1405548c, 0x1004b011
.long 0x1680902, 0x1f80802, 0x2407f494, 0x2007601c
.long 0x1680d02, 0x1f80c02, 0x340a7494, 0x3009e01c
.long 0x481104, 0xd8120a, 0x440caa44, 0x480d744c
.long 0x1681502, 0x481602, 0x540f7494, 0x580fd244
.long 0x1681902, 0x481a12, 0x6411f494, 0x68125244
.long 0x1681d02, 0x481e1a, 0x74147494, 0x7814d244
.long 0xfc0102, 0x1560002, 0x402dc8e, 0x23813
.long 0xfc0502, 0x1560402, 0x14055c8e, 0x1004b813
.long 0x18c0902, 0x21c0802, 0x2407fc96, 0x2007681e
.long 0x18c0d02, 0x21c0c02, 0x340a7c96, 0x3009e81e
.long 0x901104, 0xfc120a, 0x440cb248, 0x480d7c4e
.long 0x18c1502, 0x6c1602, 0x540f7c96, 0x580fda46
.long 0x18c1902, 0x6c1a12, 0x6411fc96, 0x68125a46
.long 0x18c1d02, 0x6c1e1a, 0x74147c96, 0x7814da46
.long 0x1200102, 0x17a0002, 0x402e490, 0x24015
.long 0x1200502, 0x17a0402, 0x14056490, 0x1004c015
.long 0x1b00902, 0x2400802, 0x24080498, 0x20077020
.long 0x1b00d02, 0x2400c02, 0x340a8498, 0x3009f020
.long 0xd81104, 0x120120a, 0x440cba4c, 0x480d8450
.long 0x1b01502, 0x901602, 0x540f8498, 0x580fe248
.long 0x1b01902, 0x901a12, 0x64120498, 0x68126248
.long 0x1b01d02, 0x901e1a, 0x74148498, 0x7814e248
.long 0x1440102, 0x19e0002, 0x402ec92, 0x24817
.long 0x1440502, 0x19e0402, 0x14056c92, 0x1004c817
.long 0x1d40902, 0x2640802, 0x24080c9a, 0x20077822
.long 0x1d40d02, 0x2640c02, 0x340a8c9a, 0x3009f822
.long 0x1201104, 0x144120a, 0x440cc250, 0x480d8c52
.long 0x1d41502, 0x1404, 0x540f8c9a, 0x500e8240
.long 0x1d41902, 0x1814, 0x64120c9a, 0x60110240
.long 0x1d41d02, 0x1c1c, 0x74148c9a, 0x70138240
.long 0x1680102, 0x1c20002, 0x402f494, 0x25019
.long 0x1680502, 0x1c20402, 0x14057494, 0x1004d019
.long 0x1f80902, 0xa02, 0x2408149c, 0x28084000
.long 0x1f80d02, 0xe02, 0x340a949c, 0x380ac000
.long 0x1681104, 0x168120a, 0x440cca54, 0x480d9454
.long 0x1f81502, 0x481404, 0x540f949c, 0x500e8a44
.long 0x1f81902, 0x481814, 0x6412149c, 0x60110a44
.long 0x1f81d02, 0x481c1c, 0x7414949c, 0x70138a44
.long 0x18c0102, 0x1e60002, 0x402fc96, 0x2581b
.long 0x18c0502, 0x1e60402, 0x14057c96, 0x1004d81b
.long 0x21c0902, 0x240a02, 0x24081c9e, 0x28084802
.long 0x21c0d02, 0x240e02, 0x340a9c9e, 0x380ac802
.long 0x1b01104, 0x18c120a, 0x440cd258, 0x480d9c56
.long 0x21c1502, 0x901404, 0x540f9c9e, 0x500e9248
.long 0x21c1902, 0x901814, 0x64121c9e, 0x60111248
.long 0x21c1d02, 0x901c1c, 0x74149c9e, 0x70139248
.long 0x1b00102, 0x20a0002, 0x4030418, 0x2601d
.long 0x1b00502, 0x20a0402, 0x14058418, 0x1004e01d
.long 0x480a02, 0xb02, 0x28085404, 0x2c08e000
.long 0x480e02, 0xf02, 0x380ad404, 0x3c0b6000
.long 0x1f81104, 0x1b0120a, 0x440cdc5c, 0x480da458
.long 0x2401502, 0xd81404, 0x540fa3a0, 0x500e9a4c
.long 0x2401902, 0xd81814, 0x641223a0, 0x60111a4c
.long 0x2401d02, 0xd81c1c, 0x7414a3a0, 0x70139a4c
.long 0x1d40102, 0x22e0002, 0x4030c1a, 0x2681f
.long 0x1d40502, 0x22e0402, 0x14058c1a, 0x1004e81f
.long 0x6c0a02, 0x240b02, 0x28085c06, 0x2c08e802
.long 0x6c0e02, 0x240f02, 0x380adc06, 0x3c0b6802
.long 0x2401104, 0x1d4120a, 0x440ce460, 0x480dac5a
.long 0x2641502, 0x1201404, 0x540faba2, 0x500ea250
.long 0x2641902, 0x1201814, 0x64122ba2, 0x60112250
.long 0x2641d02, 0x1201c1c, 0x7414aba2, 0x7013a250
.long 0x1f80102, 0x2520002, 0x403141c, 0x27021
.long 0x1f80502, 0x2520402, 0x1405941c, 0x1004f021
.long 0x900a02, 0x480b02, 0x28086408, 0x2c08f004
.long 0x900e02, 0x480f02, 0x380ae408, 0x3c0b7004
.long 0x2104, 0x1f8120a, 0x8416a440, 0x480db45c
.long 0x1703, 0x2004, 0x5c106380, 0x80160240
.long 0x1b03, 0x2214, 0x6c12e380, 0x88174240
.long 0x1f03, 0x231c, 0x7c156380, 0x8c17e240
.long 0x21c0102, 0x202, 0x4031c1e, 0x8034000
.long 0x21c0502, 0x602, 0x14059c1e, 0x1805c000
.long 0xb40a02, 0x6c0b02, 0x28086c0a, 0x2c08f806
.long 0xb40e02, 0x6c0f02, 0x380aec0a, 0x3c0b7806
.long 0x18c2102, 0x100c, 0x8416f456, 0x400c0440
.long 0x361703, 0x482004, 0x5c106b83, 0x80160a44
.long 0x361b03, 0x482214, 0x6c12eb83, 0x88174a44
.long 0x361f03, 0x48231c, 0x7c156b83, 0x8c17ea44
.long 0x2400102, 0x240202, 0x4032420, 0x8034802
.long 0x2400502, 0x240602, 0x1405a420, 0x1805c802
.long 0xd80a02, 0x900b02, 0x2808740c, 0x2c090008
.long 0xd80e02, 0x900f02, 0x380af40c, 0x3c0b8008
.long 0x1b02102, 0x48100c, 0x8416fc58, 0x400c0c44
.long 0x6c1703, 0x902004, 0x5c107386, 0x80161248
.long 0x6c1b03, 0x902214, 0x6c12f386, 0x88175248
.long 0x6c1f03, 0x90231c, 0x7c157386, 0x8c17f248
.long 0x2640102, 0x480202, 0x4032c22, 0x8035004
.long 0x2640502, 0x480602, 0x1405ac22, 0x1805d004
.long 0xfc0a02, 0xb40b02, 0x28087c0e, 0x2c09080a
.long 0xfc0e02, 0xb40f02, 0x380afc0e, 0x3c0b880a
.long 0x1d42102, 0x90100c, 0x8417045a, 0x400c1448
.long 0xb41603, 0xa21704, 0x580feb8a, 0x5c107a49
.long 0xb41a03, 0xa21b14, 0x68126b8a, 0x6c12fa49
.long 0xb41e03, 0xa21f1c, 0x7814eb8a, 0x7c157a49
.long 0x1440202, 0xd80302, 0x8037c12, 0xc04000c
.long 0x1440602, 0xd80702, 0x1805fc12, 0x1c06800c
.long 0x1200a02, 0xd80b02, 0x28088410, 0x2c09100c
.long 0x1200e02, 0xd80f02, 0x380b0410, 0x3c0b900c
.long 0x1f82102, 0xd8100c, 0x84170c5c, 0x400c1c4c
.long 0xea1603, 0xd82004, 0x580ff38d, 0x80161a4c
.long 0xea1a03, 0xd82214, 0x6812738d, 0x88175a4c
.long 0xea1e03, 0xd8231c, 0x7814f38d, 0x8c17fa4c
.long 0x1680202, 0xfc0302, 0x8038414, 0xc04080e
.long 0x1680602, 0xfc0702, 0x18060414, 0x1c06880e
.long 0x1440a02, 0xfc0b02, 0x28088c12, 0x2c09180e
.long 0x1440e02, 0xfc0f02, 0x380b0c12, 0x3c0b980e
.long 0x21c2102, 0x120100c, 0x8417145e, 0x400c2450
.long 0x1201603, 0xea1704, 0x580ffb90, 0x5c10824d
.long 0x1201a03, 0xea1b14, 0x68127b90, 0x6c13024d
.long 0x1201e03, 0xea1f1c, 0x7814fb90, 0x7c15824d
.long 0x18c0202, 0x1200302, 0x8038b96, 0xc041010
.long 0x18c0602, 0x1200702, 0x18060b96, 0x1c069010
.long 0x1680a02, 0x1200b02, 0x28089394, 0x2c092010
.long 0x1680e02, 0x1200f02, 0x380b1394, 0x3c0ba010
.long 0x2402102, 0x168100c, 0x84171aa0, 0x400c2c54
.long 0x1321703, 0x1202004, 0x5c108a91, 0x80162250
.long 0x1321b03, 0x1202214, 0x6c130a91, 0x88176250
.long 0x1321f03, 0x120231c, 0x7c158a91, 0x8c180250
.long 0x1b00202, 0x1440302, 0x8039398, 0xc041812
.long 0x1b00602, 0x1440702, 0x18061398, 0x1c069812
.long 0x18c0a02, 0x1440b02, 0x28089b96, 0x2c092812
.long 0x18c0e02, 0x1440f02, 0x380b1b96, 0x3c0ba812
.long 0x2642102, 0x1b0100c, 0x841722a2, 0x400c3458
.long 0x1561603, 0x1681704, 0x58100293, 0x5c109254
.long 0x1561a03, 0x1681b14, 0x68128293, 0x6c131254
.long 0x1561e03, 0x1681f1c, 0x78150293, 0x7c159254
.long 0x1d40202, 0x1680302, 0x8039b9a, 0xc042014
.long 0x1d40602, 0x1680702, 0x18061b9a, 0x1c06a014
.long 0x2400902, 0x804, 0x240823a0, 0x20070000
.long 0x2400d02, 0xc04, 0x340aa3a0, 0x30098000
.long 0x21c1203, 0x130c, 0x480dba9e, 0x4c0de440
.long 0x18c1603, 0x1682004, 0x58100a96, 0x80162a54
.long 0x18c1a03, 0x1682214, 0x68128a96, 0x88176a54
.long 0x18c1e03, 0x168231c, 0x78150a96, 0x8c180a54
.long 0x1f80202, 0x18c0302, 0x803a39c, 0xc042816
.long 0x1f80602, 0x18c0702, 0x1806239c, 0x1c06a816
.long 0x2640902, 0x480804, 0x24082ba2, 0x20070804
.long 0x2640d02, 0x480c04, 0x340aaba2, 0x30098804
.long 0x2521203, 0x48130c, 0x480dc2a1, 0x4c0dec44
.long 0x1b01703, 0x1b02004, 0x5c109a98, 0x80163258
.long 0x1b01b03, 0x1b02214, 0x6c131a98, 0x88177258
.long 0x1b01f03, 0x1b0231c, 0x7c159a98, 0x8c181258
.long 0x21c0202, 0x1b00302, 0x803ab9e, 0xc043018
.long 0x21c0602, 0x1b00702, 0x18062b9e, 0x1c06b018
.long 0x1b00a03, 0x1680b04, 0x2808a398, 0x2c093014
.long 0x1b00e03, 0x1680f04, 0x380b2398, 0x3c0bb014
.long 0x901303, 0xc6130c, 0x4c0df288, 0x4c0dfc4b
.long 0x1c21603, 0x1e61704, 0x58101299, 0x5c10a25b
.long 0x1c21a03, 0x1e61b14, 0x68129299, 0x6c13225b
.long 0x1c21e03, 0x1e61f1c, 0x78151299, 0x7c15a25b
.long 0x2400202, 0x1d40302, 0x803b3a0, 0xc04381a
.long 0x2400602, 0x1d40702, 0x180633a0, 0x1c06b81a
.long 0x1e60a03, 0x1b00b04, 0x2808ab9b, 0x2c093818
.long 0x1e60e03, 0x1b00f04, 0x380b2b9b, 0x3c0bb818
.long 0x10e1303, 0x144130c, 0x4c0e028f, 0x4c0e0c52
.long 0x1f81603, 0x1f82004, 0x58101a9c, 0x80163a5c
.long 0x1f81a03, 0x1f82214, 0x68129a9c, 0x88177a5c
.long 0x1f81e03, 0x1f8231c, 0x78151a9c, 0x8c181a5c
.long 0x1f80303, 0x2760001, 0xc04439c, 0x27823
.long 0x1f80703, 0x2760401, 0x1c06c39c, 0x1004f823
.long 0x21c0a03, 0x1f80b04, 0x2808b39e, 0x2c09401c
.long 0x21c0e03, 0x1f80f04, 0x380b339e, 0x3c0bc01c
.long 0x18c1303, 0x1c2130c, 0x4c0e1296, 0x4c0e1c59
.long 0x22e1603, 0x2402004, 0x5810229f, 0x80164260
.long 0x22e1a03, 0x2402214, 0x6812a29f, 0x88178260
.long 0x22e1e03, 0x240231c, 0x7815229f, 0x8c182260
.long 0x2640202, 0x22e0305, 0x803bba2, 0xc04481f
.long 0x2640602, 0x22e0705, 0x18063ba2, 0x1c06c81f
.long 0x2520a03, 0x2400b04, 0x2808bba1, 0x2c094820
.long 0x2520e03, 0x2400f04, 0x380b3ba1, 0x3c0bc820
.long 0x20a1303, 0x240130c, 0x4c0e229d, 0x4c0e2c60
.long 0x2641602, 0x22e1705, 0x58102aa2, 0x5c10aa5f
.long 0x2641a02, 0x22e1b15, 0x6812aaa2, 0x6c132a5f
.long 0x2641e02, 0x22e1f1d, 0x78152aa2, 0x7c15aa5f
.size TABLE, 4096
.section .rodata,"a"
.p2align 6
.amdhsa_kernel standalone__weight_only_int_quip__decode_kernel
  .amdhsa_next_free_vgpr 256
  .amdhsa_next_free_sgpr 102
  .amdhsa_accum_offset 256
  .amdhsa_group_segment_fixed_size 0
  .amdhsa_kernarg_size 72
  .amdhsa_user_sgpr_count 2
  .amdhsa_user_sgpr_kernarg_segment_ptr 1
  .amdhsa_system_sgpr_workgroup_id_x 1
  .amdhsa_float_denorm_mode_32 3
.end_amdhsa_kernel
```
